```python
import torch

def _softmax(x, axis=-1):
    return torch.softmax(x, dim=axis)
def _gelu(x):
    return torch.nn.functional.gelu(x, approximate="tanh")
def _silu(x):
    return torch.nn.functional.silu(x)
def _sigmoid(x):
    return torch.sigmoid(x)
def _layernorm(x, axis=-1, eps=1e-5):
    m = x.mean(dim=axis, keepdim=True)
    v = x.var(dim=axis, keepdim=True, unbiased=False)
    return (x - m) / torch.sqrt(v + eps)
def _scatter_add(tgt, idx, src, axis=0):
    return tgt.clone().index_add_(axis, idx, src)
def _segment_sum(src, seg, n):
    out = torch.zeros((n,) + src.shape[1:], dtype=src.dtype)
    return out.index_add_(0, seg, src)
def _pad(x, pw):
    flat = tuple(v for pair in reversed(pw) for v in pair)
    return torch.nn.functional.pad(x, flat)

kernel_name = 'standalone__sliding_block_cached__sampling'

def setup_inputs():

    _w = (lambda a: (lambda t: t.to(torch.bfloat16) if t.is_floating_point() else t)(torch.as_tensor(a)))
    B, Sq, D = 8, 8, 448
    Hq, Hkv, Sk, Dh = 16, 8, 8192, 256
    assert Hq % Hkv == 0, (Hq, Hkv)
    return {
        "x": _w((lambda *s: torch.randn(*s, dtype=torch.bfloat16) * 0.8)(B, Sq, D)),
        "k_cache": _w((lambda *s: torch.randn(*s, dtype=torch.bfloat16) * 0.8)(B, Hkv, Sk, Dh)),
        "v_cache": _w((lambda *s: torch.randn(*s, dtype=torch.bfloat16) * 0.05)(B, Hkv, Sk, Dh)),
        "wq": _w((lambda *s: torch.randn(*s, dtype=torch.bfloat16) * 0.8)(D, Hq * Dh) * (D ** -0.5)),
        "wo": _w((lambda *s: torch.randn(*s, dtype=torch.bfloat16) * 0.05)(Hq * Dh, D) * ((Hq * Dh) ** -0.5)),
    }

def reference(x, k_cache, v_cache, wq, wo):
    B, Sq, D = x.shape
    Hq, Dh = 16, 256
    Hkv, Sk = k_cache.shape[1], k_cache.shape[2]
    W = min(4096, max(256, Sk // 4))
    rep = Hq // Hkv
    q = (lambda x, *d: x.permute(*d))((x @ wq).reshape(B, Sq, Hq, Dh), 0, 2, 1, 3)
    k = (lambda x, n, axis: torch.repeat_interleave(x, n, dim=axis))(k_cache[:, :, Sk - W:, :], rep, axis=1)
    v = (lambda x, n, axis: torch.repeat_interleave(x, n, dim=axis))(v_cache[:, :, Sk - W:, :], rep, axis=1)
    scores = torch.einsum("bhqd,bhkd->bhqk", q, k) * (Dh ** -0.5)
    p = _softmax(scores, axis=-1)
    o = torch.einsum("bhqk,bhkd->bhqd", p, v)
    return (lambda x, *d: x.permute(*d))(o, 0, 2, 1, 3).reshape(B, Sq, Hq * Dh) @ wo
```

```asm
; @launch grid=(256,1,1) block=(512,1,1) lds=163840
.amdgcn_target "amdgcn-amd-amdhsa--gfx950"
.text
.globl standalone__sliding_block_cached__sampling_kernel
.p2align 8
.type standalone__sliding_block_cached__sampling_kernel,@function
standalone__sliding_block_cached__sampling_kernel:
s_cmp_ge_u32 s2, 256
s_cbranch_scc1 L_end
s_load_dwordx16 s[8:23], s[0:1], 0
v_lshrrev_b32 v2, 6, v0
v_and_b32 v1, 63, v0
v_readfirstlane_b32 s28, v2
s_lshr_b32 s89, s2, 3
v_lshlrev_b32 v12, 7, v1
s_getpc_b64 s[36:37]
L_pc:
s_mov_b32 s38, L_end-L_pc
s_mov_b32 s39, 0x20000
s_lshl_b32 s3, s89, 9
s_cmp_lg_u32 s28, 3
s_cbranch_scc1 L_o1
s_mov_b64 exec, 15
buffer_load_dword v31, v12, s[36:39], s3 offen
s_mov_b64 exec, -1
L_o1:
s_and_b32 s26, s2, 7
s_and_b32 s24, s89, 3
s_lshr_b32 s27, s2, 5
s_lshl_b32 s25, s27, 3
s_add_u32 s25, s25, s26
s_lshl_b32 s2, s25, 2
s_add_u32 s2, s2, s24
v_and_b32 v3, 15, v1
v_lshrrev_b32 v4, 4, v1
v_lshrrev_b32 v5, 1, v3
v_lshlrev_b32 v5, 9, v5
v_and_b32 v6, 1, v3
v_lshl_or_b32 v5, v6, 6, v5
v_lshl_or_b32 v5, v4, 4, v5
s_lshl_b32 s29, s25, 22
s_lshl_b32 s3, s24, 18
s_add_u32 s29, s29, s3
s_add_u32 s29, s29, 0x300000
s_add_u32 s90, s89, s28
s_and_b32 s90, s90, 7
s_lshl_b32 s90, s90, 12
s_lshl_b32 s91, s28, 15
s_add_u32 s90, s90, s91
s_mov_b32 s34, 0x40000
s_mov_b32 s35, 0x20000
s_mov_b32 s42, 3670016
s_mov_b32 s43, 0x20000
s_mov_b32 s46, 57344
s_mov_b32 s47, 0x20000
v_lshrrev_b32 v10, 3, v1
v_lshlrev_b32 v13, 13, v10
v_and_b32 v8, 7, v1
v_lshl_or_b32 v14, v8, 7, v13
s_lshl_b32 s95, s89, 1
s_add_u32 s95, s95, s28
s_mul_i32 s95, s95, 57344
s_lshl_b32 s31, s26, 10
s_add_u32 s95, s95, s31
s_mul_i32 s94, s89, 1792
s_waitcnt lgkmcnt(0)
s_mov_b32 s40, s14
s_mov_b32 s41, s15
s_mov_b32 s44, s8
s_mov_b32 s45, s9
s_add_u32 s32, s10, s29
s_addc_u32 s33, s11, 0
s_cmp_ge_u32 s28, 2
s_cbranch_scc1 L_o2
s_mov_b32 exec_hi, 0xffffff
buffer_load_dword v30, v14, s[40:43], s95 offen
s_mov_b32 exec_hi, -1
L_o2:
s_cmp_lg_u32 s28, 2
s_cbranch_scc1 L_o3
s_mov_b64 exec, 0x3fff
buffer_load_dword v30, v12, s[44:47], s94 offen
s_mov_b64 exec, -1
L_o3:
buffer_load_dwordx4 v[128:131], v5, s[32:35], s90 offen offset:0 nt
buffer_load_dwordx4 v[132:135], v5, s[32:35], s90 offen offset:128 nt
buffer_load_dwordx4 v[136:139], v5, s[32:35], s90 offen offset:256 nt
buffer_load_dwordx4 v[140:143], v5, s[32:35], s90 offen offset:384 nt
s_xor_b32 s4, s90, 4096
buffer_load_dwordx4 v[144:147], v5, s[32:35], s4 offen offset:0 nt
s_lshr_b32 s63, s27, 1
s_lshl_b32 s3, s63, 7
s_add_u32 s92, s22, s3
s_addc_u32 s93, s23, 0
s_load_dword s62, s[92:93], 0
s_and_b32 s30, s89, 7
s_lshl_b32 s3, s30, 7
s_add_u32 s31, s31, s3
s_lshl_b32 s3, s28, 19
s_add_u32 s31, s31, s3
s_mul_i32 s88, s63, 14336
s_lshl_b32 s3, s28, 7
s_add_u32 s88, s88, s3
v_bfe_u32 v12, v1, 4, 1
v_xor_b32 v12, v12, v8
v_lshlrev_b32 v12, 4, v12
v_add_u32 v8, v13, v12
v_mul_u32_u24 v15, 896, v10
v_add_u32 v15, v15, v12
v_mul_u32_u24 v9, 896, v3
v_lshl_add_u32 v9, v4, 4, v9
v_lshlrev_b32 v6, 10, v4
v_lshl_or_b32 v6, v3, 4, v6
v_and_b32 v10, 1, v2
v_lshl_or_b32 v6, v10, 8, v6
v_lshl_add_u32 v2, v2, 7, v15
v_lshlrev_b32 v11, 4, v1
s_add_u32 s7, s28, 1
s_and_b32 s7, s7, 7
s_lshl_b32 s7, s7, 14
s_add_u32 s7, s7, 32768
s_mov_b32 s100, 0
s_getreg_b32 s99, hwreg(HW_REG_XCC_ID)
s_and_b32 s99, s99, 15
s_and_b32 s101, s89, 3
s_and_b32 s5, s89, 3
s_mov_b32 s52, s22
s_mov_b32 s53, s23
s_mov_b32 s54, 16777216
s_mov_b32 s55, 0x20000
s_add_u32 s36, s12, s29
s_addc_u32 s37, s13, 0
s_mov_b32 s38, 262144
s_mov_b32 s39, 0x20000
s_mov_b32 s48, s16
s_mov_b32 s49, s17
s_mov_b32 s50, 3670016
s_mov_b32 s51, 0x20000
s_mov_b32 s56, s18
s_mov_b32 s57, s19
s_mov_b32 s58, 57344
s_mov_b32 s59, 0x20000
s_mov_b32 s64, 0x05040100
s_mov_b32 s65, 0x07060302
s_mov_b32 s66, 1035512379
s_and_b32 s94, s28, 6
s_add_u32 s95, s94, 0
s_add_u32 s98, s95, s89
s_and_b32 s98, s98, 7
s_lshl_b32 s98, s98, 12
s_lshl_b32 s95, s95, 15
s_add_u32 s72, s98, s95
s_add_u32 s95, s94, 1
s_add_u32 s98, s95, s89
s_and_b32 s98, s98, 7
s_lshl_b32 s98, s98, 12
s_lshl_b32 s95, s95, 15
s_add_u32 s73, s98, s95
s_bitcmp1_b32 s28, 0
s_cselect_b32 s98, s73, s72
s_cselect_b32 s73, s72, s73
s_mov_b32 s72, s98
s_lshl_b32 s70, s26, 2
s_add_u32 s70, s70, s24
s_mul_i32 s70, s70, 114688
v_and_b32 v47, 7, v1
v_lshlrev_b32 v47, 3, v47
s_mov_b32 s3, 0x9E3779B1
v_mul_lo_u32 v47, v47, s3
v_add_u32 v47, s3, v47
v_or_b32 v40, 0x10001, v47
v_add_u32 v47, s3, v47
v_or_b32 v41, 0x10001, v47
v_add_u32 v47, s3, v47
v_or_b32 v42, 0x10001, v47
v_add_u32 v47, s3, v47
v_or_b32 v43, 0x10001, v47
v_add_u32 v47, s3, v47
v_or_b32 v44, 0x10001, v47
v_add_u32 v47, s3, v47
v_or_b32 v45, 0x10001, v47
v_add_u32 v47, s3, v47
v_or_b32 v46, 0x10001, v47
v_add_u32 v47, s3, v47
v_or_b32 v47, 0x10001, v47
s_waitcnt lgkmcnt(0)
s_add_u32 s62, s62, 1
s_or_b32 s60, s62, 0x80000000
s_not_b32 s61, s60
s_lshl_b32 s15, s63, 3
s_add_u32 s15, s15, s26
s_lshl_b32 s15, s15, 7
s_add_u32 s15, s15, 4096
s_lshl_b32 s16, s60, 4
s_or_b32 s16, s16, s99
s_cmp_lg_u32 s28, 5
s_cbranch_scc1 L_o4
s_lshl_b32 s3, s30, 2
v_mov_b32 v22, s3
v_mov_b32 v23, s16
s_mov_b64 exec, 1
buffer_store_dword v23, v22, s[52:55], s15 offen
s_mov_b64 exec, -1
L_o4:
s_waitcnt vmcnt(4)
buffer_load_dwordx4 v[148:151], v5, s[32:35], s4 offen offset:128 nt
s_waitcnt vmcnt(4)
buffer_load_dwordx4 v[152:155], v5, s[32:35], s4 offen offset:256 nt
s_cmp_lg_u32 s101, 0
s_cbranch_scc1 L_ns7
s_call_b64 s[92:93], L_wburst
L_ns7:
s_sub_u32 s100, s100, 1
s_cbranch_scc0 L_sk8
s_mov_b32 s100, 0
s_waitcnt vmcnt(4)
L_sk8:
buffer_load_dwordx4 v[156:159], v5, s[32:35], s4 offen offset:384 nt
s_mov_b64 exec, 0
s_cmp_eq_u32 s28, 0
s_cbranch_scc1 L_seg0
s_cmp_eq_u32 s28, 1
s_cbranch_scc1 L_seg1
s_cmp_eq_u32 s28, 2
s_cbranch_scc1 L_seg2
s_cmp_eq_u32 s28, 3
s_cbranch_scc1 L_seg3
s_cmp_eq_u32 s28, 4
s_cbranch_scc1 L_seg4
s_cmp_eq_u32 s28, 5
s_cbranch_scc1 L_seg5
s_cmp_eq_u32 s28, 6
s_cbranch_scc1 L_seg6
s_branch L_seg7
L_chainback:
s_mov_b64 exec, -1
s_sub_u32 s100, s100, 1
s_cbranch_scc0 L_sk9
s_mov_b32 s100, 0
s_waitcnt vmcnt(4)
L_sk9:
s_xor_b32 s4, s90, 8192
buffer_load_dwordx4 v[160:163], v5, s[32:35], s4 offen offset:0 nt
s_cmp_lg_u32 s94, 2
s_cbranch_scc1 L_o5
v_lshlrev_b32 v22, 7, v1
s_lshl_b32 s95, s27, 1
s_add_u32 s95, s95, s28
s_sub_u32 s95, s95, 2
s_mul_i32 s95, s95, 7168
s_add_u32 s95, s95, s70
s_mov_b32 exec_hi, 0xffffff
buffer_load_dword v25, v22, s[48:51], s95 offen
s_mov_b32 exec_hi, -1
L_o5:
s_cmp_lg_u32 s28, 4
s_cbranch_scc1 L_o6
v_and_b32 v22, 31, v1
v_lshlrev_b32 v22, 13, v22
s_lshl_b32 s3, s27, 18
s_add_u32 s3, s3, 4201984
v_add_u32 v22, s3, v22
v_and_b32 v23, 3, v1
v_mul_u32_u24 v23, 9216, v23
s_mul_i32 s3, s25, 36864
s_add_u32 s3, s3, 1057280
v_add_u32 v23, s3, v23
L_seg0:
L_pad0:
s_cbranch_execz L_pad1
v_cmp_le_u32 vcc, 2, v4
s_nop 1
v_cndmask_b32 v22, v22, v23, vcc
buffer_load_dword v23, v22, s[52:55], 0 offen sc1
v_mov_b32 v22, 0
s_mov_b64 exec, 1
buffer_load_dword v24, v22, s[56:59], 0 offen sc1
buffer_load_dword v25, v22, s[36:39], 0 offen nt
s_mov_b64 exec, -1
L_o6:
s_cmp_lg_u32 s28, 6
s_cbranch_scc1 L_o10
v_lshlrev_b32 v22, 7, v1
s_lshl_b32 s3, s2, 13
s_add_u32 s3, s3, 4201472
s_mov_b64 exec, 15
buffer_load_dword v23, v22, s[52:55], s3 offen
s_mov_b64 exec, -1
L_o10:
s_cmp_lg_u32 s28, 7
s_cbranch_scc1 L_o11
v_mov_b32 v22, 0
s_lshl_b32 s3, s2, 7
s_add_u32 s3, s3, 1015808
s_mov_b64 exec, 1
buffer_load_dword v23, v22, s[52:55], s3 offen
s_mov_b64 exec, -1
L_o11:
s_sub_u32 s100, s100, 1
s_cbranch_scc0 L_sk12
s_mov_b32 s100, 0
s_waitcnt vmcnt(4)
L_sk12:
buffer_load_dwordx4 v[164:167], v5, s[32:35], s4 offen offset:128 nt
L_pad1:
s_cbranch_execz L_pad2
s_sub_u32 s100, s100, 1
s_cbranch_scc0 L_sk13
s_mov_b32 s100, 0
s_waitcnt vmcnt(4)
L_sk13:
buffer_load_dwordx4 v[168:171], v5, s[32:35], s4 offen offset:256 nt
s_cmp_lg_u32 s101, 1
s_cbranch_scc1 L_ns14
s_call_b64 s[92:93], L_wburst
L_ns14:
s_sub_u32 s100, s100, 1
s_cbranch_scc0 L_sk15
s_mov_b32 s100, 0
s_waitcnt vmcnt(4)
L_sk15:
buffer_load_dwordx4 v[172:175], v5, s[32:35], s4 offen offset:384 nt
s_sub_u32 s100, s100, 1
s_cbranch_scc0 L_sk16
s_mov_b32 s100, 0
s_waitcnt vmcnt(4)
L_sk16:
s_xor_b32 s4, s90, 12288
buffer_load_dwordx4 v[176:179], v5, s[32:35], s4 offen offset:0 nt
s_sub_u32 s100, s100, 1
s_cbranch_scc0 L_sk17
s_mov_b32 s100, 0
s_waitcnt vmcnt(4)
L_sk17:
buffer_load_dwordx4 v[180:183], v5, s[32:35], s4 offen offset:128 nt
s_sub_u32 s100, s100, 1
s_cbranch_scc0 L_sk18
s_mov_b32 s100, 0
s_waitcnt vmcnt(4)
L_sk18:
buffer_load_dwordx4 v[184:187], v5, s[32:35], s4 offen offset:256 nt
s_cmp_lg_u32 s101, 2
L_pad2:
s_cbranch_execz L_pad3
s_cbranch_scc1 L_ns19
s_call_b64 s[92:93], L_wburst
L_ns19:
s_sub_u32 s100, s100, 1
s_cbranch_scc0 L_sk20
s_mov_b32 s100, 0
s_waitcnt vmcnt(4)
L_sk20:
buffer_load_dwordx4 v[188:191], v5, s[32:35], s4 offen offset:384 nt
s_sub_u32 s100, s100, 1
s_cbranch_scc0 L_sk21
s_mov_b32 s100, 0
s_waitcnt vmcnt(4)
L_sk21:
s_xor_b32 s4, s90, 16384
buffer_load_dwordx4 v[192:195], v5, s[32:35], s4 offen offset:0 nt
s_sub_u32 s100, s100, 1
s_cbranch_scc0 L_sk22
s_mov_b32 s100, 0
s_waitcnt vmcnt(4)
L_sk22:
buffer_load_dwordx4 v[196:199], v5, s[32:35], s4 offen offset:128 nt
s_sub_u32 s100, s100, 1
s_cbranch_scc0 L_sk23
s_mov_b32 s100, 0
s_waitcnt vmcnt(4)
L_sk23:
buffer_load_dwordx4 v[200:203], v5, s[32:35], s4 offen offset:256 nt
s_cmp_lg_u32 s101, 3
s_cbranch_scc1 L_ns24
s_call_b64 s[92:93], L_wburst
L_ns24:
s_sub_u32 s100, s100, 1
s_cbranch_scc0 L_sk25
s_mov_b32 s100, 0
s_waitcnt vmcnt(4)
L_sk25:
L_pad3:
s_cbranch_execz L_pad4
buffer_load_dwordx4 v[204:207], v5, s[32:35], s4 offen offset:384 nt
s_cmp_ge_u32 s28, 2
s_cbranch_scc1 L_o26
v_and_b32 v26, 7, v1
v_lshlrev_b32 v26, 2, v26
buffer_load_dword v27, v26, s[52:55], s15 offen sc1
L_o26:
s_sub_u32 s100, s100, 1
s_cbranch_scc0 L_sk27
s_mov_b32 s100, 0
s_waitcnt vmcnt(4)
L_sk27:
s_xor_b32 s4, s90, 20480
buffer_load_dwordx4 v[208:211], v5, s[32:35], s4 offen offset:0 nt
s_sub_u32 s100, s100, 1
s_cbranch_scc0 L_sk28
s_mov_b32 s100, 0
s_waitcnt vmcnt(4)
L_sk28:
buffer_load_dwordx4 v[212:215], v5, s[32:35], s4 offen offset:128 nt
s_sub_u32 s100, s100, 1
s_cbranch_scc0 L_sk29
s_mov_b32 s100, 0
s_waitcnt vmcnt(4)
L_sk29:
buffer_load_dwordx4 v[216:219], v5, s[32:35], s4 offen offset:256 nt
s_sub_u32 s100, s100, 1
s_cbranch_scc0 L_sk30
s_mov_b32 s100, 0
s_waitcnt vmcnt(4)
L_sk30:
buffer_load_dwordx4 v[220:223], v5, s[32:35], s4 offen offset:384 nt
s_waitcnt vmcnt(4)
s_cmp_eq_u32 s28, 7
s_cbranch_scc1 L_noqmm
L_pad4:
s_cbranch_execz L_pad5
v_bfe_u32 v12, v1, 2, 2
v_lshl_add_u32 v12, v4, 3, v12
v_lshlrev_b32 v12, 7, v12
v_add_u32 v12, s7, v12
v_and_b32 v13, 3, v1
v_lshlrev_b32 v13, 1, v13
v_bfe_u32 v14, v1, 3, 1
v_xor_b32 v13, v13, v14
v_lshl_add_u32 v12, v13, 4, v12
v_xor_b32 v13, 16, v12
ds_read_b64_tr_b16 v[64:65], v12 offset:0
ds_read_b64_tr_b16 v[66:67], v12 offset:512
ds_read_b64_tr_b16 v[68:69], v12 offset:8
ds_read_b64_tr_b16 v[70:71], v12 offset:520
ds_read_b64_tr_b16 v[72:73], v13 offset:0
ds_read_b64_tr_b16 v[74:75], v13 offset:512
ds_read_b64_tr_b16 v[76:77], v13 offset:8
ds_read_b64_tr_b16 v[78:79], v13 offset:520
ds_read_b64_tr_b16 v[80:81], v12 offset:4096
ds_read_b64_tr_b16 v[82:83], v12 offset:4608
ds_read_b64_tr_b16 v[84:85], v12 offset:4104
ds_read_b64_tr_b16 v[86:87], v12 offset:4616
ds_read_b64_tr_b16 v[88:89], v13 offset:4096
ds_read_b64_tr_b16 v[90:91], v13 offset:4608
ds_read_b64_tr_b16 v[92:93], v13 offset:4104
ds_read_b64_tr_b16 v[94:95], v13 offset:4616
s_lshl_b32 s3, s28, 12
v_add_u32 v12, s3, v11
s_waitcnt lgkmcnt(8)
v_mfma_f32_16x16x32_bf16 v[112:115], v[64:67], v[96:99], 0
L_pad5:
s_cbranch_execz L_chainback
v_mfma_f32_16x16x32_bf16 v[116:119], v[68:71], v[96:99], 0
v_mfma_f32_16x16x32_bf16 v[120:123], v[72:75], v[96:99], 0
v_mfma_f32_16x16x32_bf16 v[124:127], v[76:79], v[96:99], 0
s_waitcnt lgkmcnt(0)
v_mfma_f32_16x16x32_bf16 v[112:115], v[80:83], v[100:103], v[112:115]
v_mfma_f32_16x16x32_bf16 v[116:119], v[84:87], v[100:103], v[116:119]
v_mfma_f32_16x16x32_bf16 v[120:123], v[88:91], v[100:103], v[120:123]
v_mfma_f32_16x16x32_bf16 v[124:127], v[92:95], v[100:103], v[124:127]
s_nop 7
ds_write_b128 v12, v[112:115] offset:0
ds_write_b128 v12, v[116:119] offset:1024
ds_write_b128 v12, v[120:123] offset:2048
ds_write_b128 v12, v[124:127] offset:3072
L_noqmm:
s_sub_u32 s100, s100, 1
s_cbranch_scc0 L_sk31
s_mov_b32 s100, 0
s_waitcnt vmcnt(4)
L_sk31:
s_xor_b32 s4, s90, 24576
buffer_load_dwordx4 v[224:227], v5, s[32:35], s4 offen offset:0 nt
s_waitcnt lgkmcnt(0)
s_barrier
s_cmp_ge_u32 s28, 2
s_cbranch_scc1 L_noqpub
s_and_b32 s6, s28, 1
s_lshl_b32 s3, s6, 11
v_add_u32 v12, s3, v11
ds_read_b128 v[64:67], v12 offset:0
ds_read_b128 v[68:71], v12 offset:1024
ds_read_b128 v[72:75], v12 offset:4096
ds_read_b128 v[76:79], v12 offset:5120
L_seg1:
L_pad6:
s_cbranch_execz L_pad7
ds_read_b128 v[80:83], v12 offset:8192
ds_read_b128 v[84:87], v12 offset:9216
ds_read_b128 v[88:91], v12 offset:12288
ds_read_b128 v[92:95], v12 offset:13312
ds_read_b128 v[96:99], v12 offset:16384
ds_read_b128 v[100:103], v12 offset:17408
ds_read_b128 v[104:107], v12 offset:20480
ds_read_b128 v[108:111], v12 offset:21504
ds_read_b128 v[112:115], v12 offset:24576
ds_read_b128 v[116:119], v12 offset:25600
s_lshl_b32 s3, s63, 4
s_add_u32 s3, s3, s26
s_lshl_b32 s3, s3, 9
s_lshr_b32 s95, s30, 2
s_lshl_b32 s95, s95, 3
s_add_u32 s3, s3, s95
s_and_b32 s95, s30, 3
s_lshl_b32 s95, s95, 7
s_add_u32 s3, s3, s95
s_lshl_b32 s95, s6, 4
s_add_u32 s3, s3, s95
v_lshrrev_b32 v12, 3, v3
v_lshlrev_b32 v12, 12, v12
v_lshl_add_u32 v12, v4, 5, v12
v_add_u32 v14, s3, v12
v_and_b32 v13, 7, v3
v_add_u32 v13, v14, v13
v_lshlrev_b32 v13, 4, v13
s_mov_b32 s3, 131072
s_mov_b32 s95, 655360
L_pad7:
s_cbranch_execz L_pad8
s_waitcnt lgkmcnt(0)
v_pk_add_f32 v[64:65], v[64:65], v[72:73]
v_pk_add_f32 v[66:67], v[66:67], v[74:75]
v_pk_add_f32 v[68:69], v[68:69], v[76:77]
v_pk_add_f32 v[70:71], v[70:71], v[78:79]
v_pk_add_f32 v[80:81], v[80:81], v[88:89]
v_pk_add_f32 v[82:83], v[82:83], v[90:91]
v_pk_add_f32 v[84:85], v[84:85], v[92:93]
v_pk_add_f32 v[86:87], v[86:87], v[94:95]
v_pk_add_f32 v[96:97], v[96:97], v[104:105]
v_pk_add_f32 v[98:99], v[98:99], v[106:107]
v_pk_add_f32 v[100:101], v[100:101], v[108:109]
v_pk_add_f32 v[102:103], v[102:103], v[110:111]
v_pk_add_f32 v[64:65], v[64:65], v[112:113]
v_pk_add_f32 v[66:67], v[66:67], v[114:115]
v_pk_add_f32 v[68:69], v[68:69], v[116:117]
v_pk_add_f32 v[70:71], v[70:71], v[118:119]
v_pk_add_f32 v[80:81], v[80:81], v[96:97]
v_pk_add_f32 v[82:83], v[82:83], v[98:99]
v_pk_add_f32 v[84:85], v[84:85], v[100:101]
v_pk_add_f32 v[86:87], v[86:87], v[102:103]
v_pk_add_f32 v[64:65], v[64:65], v[80:81]
v_pk_add_f32 v[66:67], v[66:67], v[82:83]
v_pk_add_f32 v[68:69], v[68:69], v[84:85]
v_pk_add_f32 v[70:71], v[70:71], v[86:87]
v_cvt_pk_bf16_f32 v16, v64, v65
v_cvt_pk_bf16_f32 v17, v66, v67
v_cvt_pk_bf16_f32 v18, v68, v69
v_cvt_pk_bf16_f32 v19, v70, v71
buffer_store_dwordx4 v[16:19], v13, s[52:55], s3 offen
L_pad8:
s_cbranch_execz L_pad9
v_dot2_u32_u16 v20, v16, v40, 0
v_dot2_u32_u16 v21, v16, v44, 0
v_dot2_u32_u16 v20, v17, v41, v20
v_dot2_u32_u16 v21, v17, v45, v21
v_dot2_u32_u16 v20, v18, v42, v20
v_dot2_u32_u16 v21, v18, v46, v21
v_dot2_u32_u16 v20, v19, v43, v20
v_dot2_u32_u16 v21, v19, v47, v21
s_nop 2
v_add_u32_dpp v20, v20, v20 quad_perm:[1,0,3,2] row_mask:0xf bank_mask:0xf
v_add_u32_dpp v21, v21, v21 quad_perm:[1,0,3,2] row_mask:0xf bank_mask:0xf
s_nop 0
v_add_u32_dpp v20, v20, v20 quad_perm:[2,3,0,1] row_mask:0xf bank_mask:0xf
v_add_u32_dpp v21, v21, v21 quad_perm:[2,3,0,1] row_mask:0xf bank_mask:0xf
s_nop 0
v_add_u32_dpp v20, v20, v20 row_half_mirror row_mask:0xf bank_mask:0xf
v_add_u32_dpp v21, v21, v21 row_half_mirror row_mask:0xf bank_mask:0xf
v_add_u32 v20, s60, v20
v_add_u32 v21, s61, v21
v_add_u32 v21, s99, v21
s_mov_b32 exec_lo, 0x01010101
s_mov_b32 exec_hi, 0x01010101
buffer_store_dwordx2 v[20:21], v14, s[52:55], s95 offen
s_mov_b64 exec, -1
s_waitcnt vmcnt(6)
v_cmp_ne_u32 vcc, s16, v27
s_cbranch_vccz L_noqpub
s_mov_b32 exec_lo, 0x01010101
s_mov_b32 exec_hi, 0x01010101
s_bitset1_b32 s3, 23
L_pad9:
s_cbranch_execz L_pad10
s_bitset1_b32 s95, 23
buffer_store_dwordx2 v[20:21], v14, s[52:55], s95 offen sc1
s_mov_b64 exec, -1
buffer_store_dwordx4 v[16:19], v13, s[52:55], s3 offen sc1
s_mov_b32 s100, 6
s_mov_b64 exec, -1
L_noqpub:
v_lshlrev_b32 v13, 4, v0
v_and_b32 v14, 0x1f8, v0
s_lshl_b32 s3, s25, 13
s_add_u32 s67, s3, 131072
s_lshl_b32 s3, s25, 9
s_add_u32 s68, s3, 655360
s_mov_b32 s69, 65536
s_sub_u32 s100, s100, 1
s_cbranch_scc0 L_sk32
s_mov_b32 s100, 0
s_waitcnt vmcnt(4)
L_sk32:
buffer_load_dwordx4 v[228:231], v5, s[32:35], s4 offen offset:128 nt
s_cmp_lg_u32 s5, 0
s_cbranch_scc1 L_ns33
s_call_b64 s[92:93], L_dburst
L_ns33:
s_sub_u32 s100, s100, 1
s_cbranch_scc0 L_sk34
s_mov_b32 s100, 0
s_waitcnt vmcnt(4)
L_sk34:
buffer_load_dwordx4 v[232:235], v5, s[32:35], s4 offen offset:256 nt
s_sub_u32 s100, s100, 1
s_cbranch_scc0 L_sk35
s_mov_b32 s100, 0
s_waitcnt vmcnt(4)
L_sk35:
L_pad10:
s_cbranch_execz L_pad11
buffer_load_dwordx4 v[236:239], v5, s[32:35], s4 offen offset:384 nt
s_sub_u32 s100, s100, 1
s_cbranch_scc0 L_sk36
s_mov_b32 s100, 0
s_waitcnt vmcnt(4)
L_sk36:
s_xor_b32 s4, s90, 28672
buffer_load_dwordx4 v[240:243], v5, s[32:35], s4 offen offset:0 nt
s_cmp_lg_u32 s5, 1
s_cbranch_scc1 L_ns37
s_call_b64 s[92:93], L_dburst
L_ns37:
s_sub_u32 s100, s100, 1
s_cbranch_scc0 L_sk38
s_mov_b32 s100, 0
s_waitcnt vmcnt(4)
L_sk38:
buffer_load_dwordx4 v[244:247], v5, s[32:35], s4 offen offset:128 nt
s_sub_u32 s100, s100, 1
s_cbranch_scc0 L_sk39
s_mov_b32 s100, 0
s_waitcnt vmcnt(4)
L_sk39:
buffer_load_dwordx4 v[248:251], v5, s[32:35], s4 offen offset:256 nt
s_sub_u32 s100, s100, 1
s_cbranch_scc0 L_sk40
s_mov_b32 s100, 0
s_waitcnt vmcnt(4)
L_sk40:
buffer_load_dwordx4 v[252:255], v5, s[32:35], s4 offen offset:384 nt
s_cmp_lg_u32 s5, 2
s_cbranch_scc1 L_ns41
s_call_b64 s[92:93], L_dburst
L_ns41:
s_sub_u32 s100, s100, 1
s_cbranch_scc0 L_sk42
L_pad11:
s_cbranch_execz L_pad12
s_mov_b32 s100, 0
s_waitcnt vmcnt(4)
L_sk42:
s_xor_b32 s4, s72, 0
buffer_load_dwordx4 v[64:67], v6, s[36:39], s4 offen offset:0 nt
buffer_load_dwordx4 v[28:31], v13, s[52:55], s67 offen sc1
buffer_load_dwordx2 v[32:33], v14, s[52:55], s68 offen sc1
s_sub_u32 s100, s100, 1
s_cbranch_scc0 L_sk43
s_mov_b32 s100, 0
s_waitcnt vmcnt(6)
L_sk43:
buffer_load_dwordx4 v[68:71], v6, s[36:39], s4 offen offset:512 nt
s_sub_u32 s100, s100, 1
s_cbranch_scc0 L_sk44
s_mov_b32 s100, 0
s_waitcnt vmcnt(6)
L_sk44:
s_xor_b32 s4, s72, 4096
buffer_load_dwordx4 v[72:75], v6, s[36:39], s4 offen offset:0 nt
s_sub_u32 s100, s100, 1
s_cbranch_scc0 L_sk45
s_mov_b32 s100, 0
s_waitcnt vmcnt(6)
L_sk45:
buffer_load_dwordx4 v[76:79], v6, s[36:39], s4 offen offset:512 nt
s_cmp_lg_u32 s5, 3
s_cbranch_scc1 L_ns46
s_call_b64 s[92:93], L_dburst
L_ns46:
s_sub_u32 s100, s100, 1
s_cbranch_scc0 L_sk47
s_mov_b32 s100, 0
s_waitcnt vmcnt(6)
L_sk47:
s_xor_b32 s4, s72, 8192
L_pad12:
s_cbranch_execz L_chainback
buffer_load_dwordx4 v[80:83], v6, s[36:39], s4 offen offset:0 nt
s_waitcnt vmcnt(4)
L_qchk:
v_dot2_u32_u16 v34, v28, v40, 0
v_dot2_u32_u16 v35, v28, v44, 0
v_dot2_u32_u16 v34, v29, v41, v34
v_dot2_u32_u16 v35, v29, v45, v35
v_dot2_u32_u16 v34, v30, v42, v34
v_dot2_u32_u16 v35, v30, v46, v35
v_dot2_u32_u16 v34, v31, v43, v34
v_dot2_u32_u16 v35, v31, v47, v35
s_nop 2
v_add_u32_dpp v34, v34, v34 quad_perm:[1,0,3,2] row_mask:0xf bank_mask:0xf
v_add_u32_dpp v35, v35, v35 quad_perm:[1,0,3,2] row_mask:0xf bank_mask:0xf
s_nop 0
v_add_u32_dpp v34, v34, v34 quad_perm:[2,3,0,1] row_mask:0xf bank_mask:0xf
v_add_u32_dpp v35, v35, v35 quad_perm:[2,3,0,1] row_mask:0xf bank_mask:0xf
s_nop 0
v_add_u32_dpp v34, v34, v34 row_half_mirror row_mask:0xf bank_mask:0xf
v_add_u32_dpp v35, v35, v35 row_half_mirror row_mask:0xf bank_mask:0xf
v_add_u32 v34, s60, v34
v_add_u32 v35, s61, v35
v_sub_u32 v36, v33, v35
v_xor_b32 v34, v32, v34
v_lshrrev_b32 v35, 4, v36
v_or_b32 v34, v34, v35
v_cmp_ne_u32 vcc, 0, v34
s_cbranch_vccz L_qok
s_sub_u32 s69, s69, 1
s_cbranch_scc1 L_qok
s_mov_b64 exec, vcc
L_seg2:
L_pad13:
s_cbranch_execz L_pad14
s_sleep 4
s_xor_b32 s67, s67, 0x800000
s_xor_b32 s68, s68, 0x800000
buffer_load_dwordx4 v[28:31], v13, s[52:55], s67 offen sc1
buffer_load_dwordx2 v[32:33], v14, s[52:55], s68 offen sc1
s_waitcnt vmcnt(0)
s_branch L_qchk
L_qok:
s_mov_b64 exec, -1
ds_write_b128 v13, v[28:31] offset:32768
v_cmp_ne_u32 vcc, s99, v36
s_cmp_eq_u64 vcc, 0
s_cselect_b32 s98, 1, 0
s_sub_u32 s100, s100, 1
s_cbranch_scc0 L_sk48
s_mov_b32 s100, 0
s_waitcnt vmcnt(6)
L_sk48:
buffer_load_dwordx4 v[84:87], v6, s[36:39], s4 offen offset:512 nt
s_waitcnt vmcnt(8)
s_waitcnt lgkmcnt(0)
s_barrier
ds_read_b128 v[32:35], v11 offset:32768
ds_read_b128 v[36:39], v11 offset:33792
ds_read_b128 v[40:43], v11 offset:34816
ds_read_b128 v[44:47], v11 offset:35840
ds_read_b128 v[48:51], v11 offset:36864
ds_read_b128 v[52:55], v11 offset:37888
ds_read_b128 v[56:59], v11 offset:38912
ds_read_b128 v[60:63], v11 offset:39936
s_xor_b32 s4, s72, 12288
buffer_load_dwordx4 v[88:91], v6, s[36:39], s4 offen offset:0 nt
L_pad14:
s_cbranch_execz L_pad15
s_waitcnt lgkmcnt(0)
v_mfma_f32_16x16x32_bf16 v[8:11], v[128:131], v[32:35], 0
v_mfma_f32_16x16x32_bf16 v[12:15], v[128:131], v[36:39], 0
v_mfma_f32_16x16x32_bf16 v[8:11], v[132:135], v[40:43], v[8:11]
v_mfma_f32_16x16x32_bf16 v[12:15], v[132:135], v[44:47], v[12:15]
v_mfma_f32_16x16x32_bf16 v[8:11], v[136:139], v[48:51], v[8:11]
v_mfma_f32_16x16x32_bf16 v[12:15], v[136:139], v[52:55], v[12:15]
v_mfma_f32_16x16x32_bf16 v[8:11], v[140:143], v[56:59], v[8:11]
v_mfma_f32_16x16x32_bf16 v[12:15], v[140:143], v[60:63], v[12:15]
s_nop 7
v_add_f32 v16, v8, v13
v_add_f32 v17, v10, v15
v_mfma_f32_16x16x32_bf16 v[8:11], v[144:147], v[32:35], 0
v_mfma_f32_16x16x32_bf16 v[12:15], v[144:147], v[36:39], 0
v_mfma_f32_16x16x32_bf16 v[8:11], v[148:151], v[40:43], v[8:11]
v_mfma_f32_16x16x32_bf16 v[12:15], v[148:151], v[44:47], v[12:15]
v_mfma_f32_16x16x32_bf16 v[8:11], v[152:155], v[48:51], v[8:11]
v_mfma_f32_16x16x32_bf16 v[12:15], v[152:155], v[52:55], v[12:15]
v_mfma_f32_16x16x32_bf16 v[8:11], v[156:159], v[56:59], v[8:11]
v_mfma_f32_16x16x32_bf16 v[12:15], v[156:159], v[60:63], v[12:15]
s_sub_u32 s100, s100, 1
s_cbranch_scc0 L_sk49
s_mov_b32 s100, 0
s_waitcnt vmcnt(5)
L_sk49:
buffer_load_dwordx4 v[92:95], v6, s[36:39], s4 offen offset:512 nt
s_nop 7
v_add_f32 v18, v8, v13
v_add_f32 v19, v10, v15
v_mfma_f32_16x16x32_bf16 v[8:11], v[160:163], v[32:35], 0
v_mfma_f32_16x16x32_bf16 v[12:15], v[160:163], v[36:39], 0
L_pad15:
s_cbranch_execz L_pad16
v_mfma_f32_16x16x32_bf16 v[8:11], v[164:167], v[40:43], v[8:11]
v_mfma_f32_16x16x32_bf16 v[12:15], v[164:167], v[44:47], v[12:15]
v_mfma_f32_16x16x32_bf16 v[8:11], v[168:171], v[48:51], v[8:11]
v_mfma_f32_16x16x32_bf16 v[12:15], v[168:171], v[52:55], v[12:15]
v_mfma_f32_16x16x32_bf16 v[8:11], v[172:175], v[56:59], v[8:11]
v_mfma_f32_16x16x32_bf16 v[12:15], v[172:175], v[60:63], v[12:15]
s_nop 7
v_add_f32 v20, v8, v13
v_add_f32 v21, v10, v15
v_mfma_f32_16x16x32_bf16 v[8:11], v[176:179], v[32:35], 0
v_mfma_f32_16x16x32_bf16 v[12:15], v[176:179], v[36:39], 0
v_mfma_f32_16x16x32_bf16 v[8:11], v[180:183], v[40:43], v[8:11]
v_mfma_f32_16x16x32_bf16 v[12:15], v[180:183], v[44:47], v[12:15]
v_mfma_f32_16x16x32_bf16 v[8:11], v[184:187], v[48:51], v[8:11]
v_mfma_f32_16x16x32_bf16 v[12:15], v[184:187], v[52:55], v[12:15]
v_mfma_f32_16x16x32_bf16 v[8:11], v[188:191], v[56:59], v[8:11]
v_mfma_f32_16x16x32_bf16 v[12:15], v[188:191], v[60:63], v[12:15]
s_sub_u32 s100, s100, 1
s_cbranch_scc0 L_sk50
s_mov_b32 s100, 0
s_waitcnt vmcnt(5)
L_sk50:
s_xor_b32 s4, s72, 16384
buffer_load_dwordx4 v[96:99], v6, s[36:39], s4 offen offset:0 nt
s_nop 7
v_add_f32 v22, v8, v13
v_add_f32 v23, v10, v15
v_mfma_f32_16x16x32_bf16 v[8:11], v[192:195], v[32:35], 0
v_mfma_f32_16x16x32_bf16 v[12:15], v[192:195], v[36:39], 0
v_mfma_f32_16x16x32_bf16 v[8:11], v[196:199], v[40:43], v[8:11]
v_mfma_f32_16x16x32_bf16 v[12:15], v[196:199], v[44:47], v[12:15]
L_pad16:
s_cbranch_execz L_pad17
v_mfma_f32_16x16x32_bf16 v[8:11], v[200:203], v[48:51], v[8:11]
v_mfma_f32_16x16x32_bf16 v[12:15], v[200:203], v[52:55], v[12:15]
v_mfma_f32_16x16x32_bf16 v[8:11], v[204:207], v[56:59], v[8:11]
v_mfma_f32_16x16x32_bf16 v[12:15], v[204:207], v[60:63], v[12:15]
s_nop 7
v_add_f32 v24, v8, v13
v_add_f32 v25, v10, v15
v_mfma_f32_16x16x32_bf16 v[8:11], v[208:211], v[32:35], 0
v_mfma_f32_16x16x32_bf16 v[12:15], v[208:211], v[36:39], 0
v_mfma_f32_16x16x32_bf16 v[8:11], v[212:215], v[40:43], v[8:11]
v_mfma_f32_16x16x32_bf16 v[12:15], v[212:215], v[44:47], v[12:15]
v_mfma_f32_16x16x32_bf16 v[8:11], v[216:219], v[48:51], v[8:11]
v_mfma_f32_16x16x32_bf16 v[12:15], v[216:219], v[52:55], v[12:15]
v_mfma_f32_16x16x32_bf16 v[8:11], v[220:223], v[56:59], v[8:11]
v_mfma_f32_16x16x32_bf16 v[12:15], v[220:223], v[60:63], v[12:15]
s_sub_u32 s100, s100, 1
s_cbranch_scc0 L_sk51
s_mov_b32 s100, 0
s_waitcnt vmcnt(5)
L_sk51:
buffer_load_dwordx4 v[100:103], v6, s[36:39], s4 offen offset:512 nt
s_nop 7
v_add_f32 v26, v8, v13
v_add_f32 v27, v10, v15
v_mfma_f32_16x16x32_bf16 v[8:11], v[224:227], v[32:35], 0
v_mfma_f32_16x16x32_bf16 v[12:15], v[224:227], v[36:39], 0
v_mfma_f32_16x16x32_bf16 v[8:11], v[228:231], v[40:43], v[8:11]
v_mfma_f32_16x16x32_bf16 v[12:15], v[228:231], v[44:47], v[12:15]
v_mfma_f32_16x16x32_bf16 v[8:11], v[232:235], v[48:51], v[8:11]
v_mfma_f32_16x16x32_bf16 v[12:15], v[232:235], v[52:55], v[12:15]
v_mfma_f32_16x16x32_bf16 v[8:11], v[236:239], v[56:59], v[8:11]
L_pad17:
s_cbranch_execz L_pad18
v_mfma_f32_16x16x32_bf16 v[12:15], v[236:239], v[60:63], v[12:15]
s_nop 7
v_add_f32 v28, v8, v13
v_add_f32 v29, v10, v15
v_mfma_f32_16x16x32_bf16 v[8:11], v[240:243], v[32:35], 0
v_mfma_f32_16x16x32_bf16 v[12:15], v[240:243], v[36:39], 0
v_mfma_f32_16x16x32_bf16 v[8:11], v[244:247], v[40:43], v[8:11]
v_mfma_f32_16x16x32_bf16 v[12:15], v[244:247], v[44:47], v[12:15]
v_mfma_f32_16x16x32_bf16 v[8:11], v[248:251], v[48:51], v[8:11]
v_mfma_f32_16x16x32_bf16 v[12:15], v[248:251], v[52:55], v[12:15]
v_mfma_f32_16x16x32_bf16 v[8:11], v[252:255], v[56:59], v[8:11]
v_mfma_f32_16x16x32_bf16 v[12:15], v[252:255], v[60:63], v[12:15]
s_sub_u32 s100, s100, 1
s_cbranch_scc0 L_sk52
s_mov_b32 s100, 0
s_waitcnt vmcnt(5)
L_sk52:
s_xor_b32 s4, s72, 20480
buffer_load_dwordx4 v[104:107], v6, s[36:39], s4 offen offset:0 nt
s_nop 7
v_add_f32 v30, v8, v13
v_add_f32 v31, v10, v15
v_max3_f32 v8, v16, v17, v18
v_max3_f32 v8, v8, v19, v20
v_max3_f32 v8, v8, v21, v22
v_max3_f32 v8, v8, v23, v24
v_max3_f32 v8, v8, v25, v26
v_max3_f32 v8, v8, v27, v28
v_max3_f32 v8, v8, v29, v30
v_max_f32 v8, v8, v31
v_mov_b32 v9, v8
L_pad18:
s_cbranch_execz L_pad19
s_nop 1
v_permlane16_swap_b32 v8, v9
s_nop 0
v_max_f32 v8, v8, v9
v_mov_b32 v9, v8
s_nop 1
v_permlane32_swap_b32 v8, v9
s_nop 0
v_max_f32 v8, v8, v9
v_lshlrev_b32 v12, 5, v3
s_lshl_b32 s3, s28, 2
v_add_u32 v13, s3, v12
ds_write_b32 v13, v8 offset:20480
v_mov_b32 v14, s3
v_mov_b32 v15, s98
ds_write_b32 v14, v15 offset:22528
s_sub_u32 s100, s100, 1
s_cbranch_scc0 L_sk53
s_mov_b32 s100, 0
s_waitcnt vmcnt(4)
L_sk53:
buffer_load_dwordx4 v[108:111], v6, s[36:39], s4 offen offset:512 nt
s_waitcnt lgkmcnt(0)
s_barrier
ds_read_b128 v[32:35], v12 offset:20480
ds_read_b128 v[36:39], v12 offset:20496
v_and_b32 v14, 7, v1
v_lshlrev_b32 v14, 2, v14
ds_read_b32 v15, v14 offset:22528
s_waitcnt lgkmcnt(0)
v_cmp_ne_u32 vcc, 1, v15
L_pad19:
s_cbranch_execz L_chainback
s_cmp_eq_u64 vcc, 0
s_cselect_b32 s98, 1, 0
v_max3_f32 v8, v32, v33, v34
v_max3_f32 v8, v8, v35, v36
v_max3_f32 v8, v8, v37, v38
v_max_f32 v8, v8, v39
v_mul_f32 v9, s66, v8
v_sub_f32 v9, 0, v9
v_fma_f32 v16, v16, s66, v9
v_fma_f32 v17, v17, s66, v9
v_fma_f32 v18, v18, s66, v9
v_fma_f32 v19, v19, s66, v9
v_fma_f32 v20, v20, s66, v9
v_fma_f32 v21, v21, s66, v9
v_fma_f32 v22, v22, s66, v9
v_fma_f32 v23, v23, s66, v9
v_fma_f32 v24, v24, s66, v9
v_fma_f32 v25, v25, s66, v9
v_fma_f32 v26, v26, s66, v9
v_fma_f32 v27, v27, s66, v9
v_fma_f32 v28, v28, s66, v9
v_fma_f32 v29, v29, s66, v9
v_fma_f32 v30, v30, s66, v9
v_fma_f32 v31, v31, s66, v9
v_exp_f32 v16, v16
v_exp_f32 v17, v17
v_exp_f32 v18, v18
v_exp_f32 v19, v19
v_exp_f32 v20, v20
v_exp_f32 v21, v21
L_seg3:
L_pad20:
s_cbranch_execz L_pad21
v_exp_f32 v22, v22
v_exp_f32 v23, v23
v_exp_f32 v24, v24
v_exp_f32 v25, v25
v_exp_f32 v26, v26
v_exp_f32 v27, v27
v_exp_f32 v28, v28
v_exp_f32 v29, v29
v_exp_f32 v30, v30
v_exp_f32 v31, v31
s_nop 0
v_add_f32 v10, v16, v17
v_add_f32 v10, v10, v18
v_add_f32 v10, v10, v19
v_add_f32 v10, v10, v20
v_add_f32 v10, v10, v21
v_add_f32 v10, v10, v22
v_add_f32 v10, v10, v23
v_add_f32 v10, v10, v24
v_add_f32 v10, v10, v25
v_add_f32 v10, v10, v26
v_add_f32 v10, v10, v27
v_add_f32 v10, v10, v28
v_add_f32 v10, v10, v29
v_add_f32 v10, v10, v30
v_add_f32 v10, v10, v31
v_cvt_pk_bf16_f32 v32, v16, v17
v_cvt_pk_bf16_f32 v33, v18, v19
v_cvt_pk_bf16_f32 v34, v20, v21
v_cvt_pk_bf16_f32 v35, v22, v23
L_pad21:
s_cbranch_execz L_pad22
v_cvt_pk_bf16_f32 v36, v24, v25
v_cvt_pk_bf16_f32 v37, v26, v27
v_cvt_pk_bf16_f32 v38, v28, v29
v_cvt_pk_bf16_f32 v39, v30, v31
v_mov_b32 v14, v10
s_nop 1
v_permlane16_swap_b32 v10, v14
s_nop 0
v_add_f32 v10, v10, v14
v_mov_b32 v14, v10
s_nop 1
v_permlane32_swap_b32 v10, v14
s_nop 0
v_add_f32 v10, v10, v14
v_lshlrev_b32 v11, 4, v1
s_lshl_b32 s3, s28, 11
v_add_u32 v14, s3, v11
s_lshr_b32 s3, s28, 2
s_lshl_b32 s3, s3, 10
s_and_b32 s95, s28, 3
s_lshl_b32 s95, s95, 2
s_add_u32 s3, s3, s95
v_add_u32 v15, s3, v11
ds_write_b32 v15, v39 offset:18432
ds_write_b128 v14, v[32:35] offset:0
ds_write_b128 v14, v[36:39] offset:1024
ds_write_b32 v13, v10 offset:20992
s_sub_u32 s100, s100, 1
s_cbranch_scc0 L_sk54
s_mov_b32 s100, 0
L_pad22:
s_cbranch_execz L_pad23
s_waitcnt vmcnt(4)
L_sk54:
s_xor_b32 s4, s72, 24576
buffer_load_dwordx4 v[112:115], v6, s[36:39], s4 offen offset:0 nt
s_waitcnt lgkmcnt(0)
s_barrier
s_lshl_b32 s3, s28, 11
v_add_u32 v14, s3, v11
v_xor_b32 v15, 0x800, v14
ds_read_b128 v[16:19], v14 offset:0
ds_read_b128 v[20:23], v14 offset:1024
ds_read_b128 v[24:27], v15 offset:0
ds_read_b128 v[28:31], v15 offset:1024
ds_read_b128 v[32:35], v12 offset:20992
ds_read_b128 v[36:39], v12 offset:21008
s_sub_u32 s100, s100, 1
s_cbranch_scc0 L_sk55
s_mov_b32 s100, 0
s_waitcnt vmcnt(4)
L_sk55:
buffer_load_dwordx4 v[116:119], v6, s[36:39], s4 offen offset:512 nt
v_and_b32 v55, 7, v1
v_lshlrev_b32 v55, 3, v55
s_mov_b32 s3, 0x9E3779B1
v_mul_lo_u32 v55, v55, s3
v_add_u32 v55, s3, v55
v_or_b32 v48, 0x10001, v55
v_add_u32 v55, s3, v55
v_or_b32 v49, 0x10001, v55
v_add_u32 v55, s3, v55
v_or_b32 v50, 0x10001, v55
v_add_u32 v55, s3, v55
L_pad23:
s_cbranch_execz L_pad24
v_or_b32 v51, 0x10001, v55
v_add_u32 v55, s3, v55
v_or_b32 v52, 0x10001, v55
v_add_u32 v55, s3, v55
v_or_b32 v53, 0x10001, v55
v_add_u32 v55, s3, v55
v_or_b32 v54, 0x10001, v55
v_add_u32 v55, s3, v55
v_or_b32 v55, 0x10001, v55
s_lshl_b32 s3, s25, 10
s_add_u32 s71, s3, 16384
s_waitcnt lgkmcnt(0)
v_add_f32 v32, v32, v33
v_add_f32 v34, v34, v35
v_add_f32 v36, v36, v37
v_add_f32 v38, v38, v39
v_add_f32 v32, v32, v34
v_add_f32 v36, v36, v38
v_add_f32 v9, v32, v36
v_mov_b32 v23, 0
v_mov_b32 v31, 0
s_cmp_lg_u32 s28, 2
s_cbranch_scc1 L_nomlpub
v_mov_b32 v60, v8
v_mov_b32 v61, v9
v_dot2_u32_u16 v62, v8, v48, s60
v_dot2_u32_u16 v63, v8, v52, s61
v_dot2_u32_u16 v62, v9, v49, v62
v_dot2_u32_u16 v63, v9, v53, v63
s_lshl_b32 s3, s24, 8
L_pad24:
s_cbranch_execz L_pad25
s_add_u32 s3, s3, s71
s_mov_b64 exec, 0xffff
s_cmp_eq_u32 s98, 1
s_cbranch_scc1 L_o56
buffer_store_dwordx4 v[60:63], v11, s[52:55], s3 offen sc1
L_o56:
s_cmp_lg_u32 s98, 1
s_cbranch_scc1 L_o57
buffer_store_dwordx4 v[60:63], v11, s[52:55], s3 offen
L_o57:
s_mov_b64 exec, -1
L_nomlpub:
s_waitcnt vmcnt(6)
v_perm_b32 v32, v68, v64, s64
v_perm_b32 v33, v76, v72, s64
v_perm_b32 v34, v84, v80, s64
v_perm_b32 v35, v92, v88, s64
v_perm_b32 v36, v68, v64, s65
v_perm_b32 v37, v76, v72, s65
v_perm_b32 v38, v84, v80, s65
v_perm_b32 v39, v92, v88, s65
v_mfma_f32_16x16x32_bf16 v[192:195], v[32:35], v[16:19], 0
v_perm_b32 v40, v69, v65, s64
v_perm_b32 v41, v77, v73, s64
v_perm_b32 v42, v85, v81, s64
v_perm_b32 v43, v93, v89, s64
v_mfma_f32_16x16x32_bf16 v[196:199], v[36:39], v[16:19], 0
v_perm_b32 v44, v69, v65, s65
v_perm_b32 v45, v77, v73, s65
v_perm_b32 v46, v85, v81, s65
v_perm_b32 v47, v93, v89, s65
v_mfma_f32_16x16x32_bf16 v[200:203], v[40:43], v[16:19], 0
v_perm_b32 v32, v70, v66, s64
L_pad25:
s_cbranch_execz L_pad26
v_perm_b32 v33, v78, v74, s64
v_perm_b32 v34, v86, v82, s64
v_perm_b32 v35, v94, v90, s64
v_mfma_f32_16x16x32_bf16 v[204:207], v[44:47], v[16:19], 0
v_perm_b32 v36, v70, v66, s65
v_perm_b32 v37, v78, v74, s65
v_perm_b32 v38, v86, v82, s65
v_perm_b32 v39, v94, v90, s65
v_mfma_f32_16x16x32_bf16 v[208:211], v[32:35], v[16:19], 0
v_perm_b32 v40, v71, v67, s64
v_perm_b32 v41, v79, v75, s64
v_perm_b32 v42, v87, v83, s64
v_perm_b32 v43, v95, v91, s64
v_mfma_f32_16x16x32_bf16 v[212:215], v[36:39], v[16:19], 0
v_perm_b32 v44, v71, v67, s65
v_perm_b32 v45, v79, v75, s65
v_perm_b32 v46, v87, v83, s65
v_perm_b32 v47, v95, v91, s65
v_mfma_f32_16x16x32_bf16 v[216:219], v[40:43], v[16:19], 0
s_nop 1
v_mfma_f32_16x16x32_bf16 v[220:223], v[44:47], v[16:19], 0
s_sub_u32 s100, s100, 1
s_cbranch_scc0 L_sk58
s_mov_b32 s100, 0
s_waitcnt vmcnt(4)
L_sk58:
s_xor_b32 s4, s73, 0
buffer_load_dwordx4 v[128:131], v6, s[36:39], s4 offen offset:0 nt
v_add_u32 v224, s7, v11
s_lshr_b32 s3, s28, 2
s_xor_b32 s3, s3, 1
L_pad26:
s_cbranch_execz L_chainback
s_lshl_b32 s3, s3, 14
s_and_b32 s95, s28, 3
s_lshl_b32 s95, s95, 8
s_add_u32 s3, s3, s95
s_add_u32 s3, s3, 32768
v_lshlrev_b32 v225, 4, v3
v_lshl_add_u32 v225, v4, 10, v225
v_add_u32 v225, s3, v225
v_add_u32 v226, 0x10000, v225
v_lshlrev_b32 v227, 4, v0
v_and_b32 v228, 0x1f8, v0
s_mul_i32 s3, s2, 9216
s_add_u32 s67, s3, 1048576
s_add_u32 s68, s67, 8192
s_sub_u32 s100, s100, 1
s_cbranch_scc0 L_sk59
s_mov_b32 s100, 0
s_waitcnt vmcnt(4)
L_sk59:
buffer_load_dwordx4 v[132:135], v6, s[36:39], s4 offen offset:512 nt
s_and_b32 s3, s24, 1
s_lshl_b32 s3, s3, 3
s_add_u32 s3, s3, s94
s_lshl_b32 s3, s3, 5
s_lshr_b32 s95, s24, 1
s_lshl_b32 s95, s95, 3
s_add_u32 s3, s3, s95
s_and_b32 s95, s28, 1
s_lshl_b32 s95, s95, 5
s_add_u32 s3, s3, s95
v_and_b32 v230, 8, v1
L_seg4:
L_pad27:
s_cbranch_execz L_pad28
v_lshlrev_b32 v230, 1, v230
v_add_u32 v230, s3, v230
v_and_b32 v229, 7, v1
v_add_u32 v235, v230, v229
v_lshlrev_b32 v235, 4, v235
v_mul_u32_u24 v237, 9216, v4
v_add_u32 v229, v237, v235
v_add_u32 v230, v237, v230
s_sub_u32 s100, s100, 1
s_cbranch_scc0 L_sk60
s_mov_b32 s100, 0
s_waitcnt vmcnt(4)
L_sk60:
s_xor_b32 s4, s73, 4096
buffer_load_dwordx4 v[136:139], v6, s[36:39], s4 offen offset:0 nt
s_mul_i32 s3, s25, 36864
s_add_u32 s74, s3, 1048576
s_add_u32 s75, s74, 8192
s_lshl_b32 s3, s2, 7
s_add_u32 s76, s3, 983040
s_add_u32 s12, s3, 1015808
s_lshl_b32 s95, s28, 4
s_add_u32 s12, s12, s95
s_lshl_b32 s3, s25, 9
s_lshl_b32 s95, s24, 2
s_add_u32 s3, s3, s95
s_add_u32 s78, s3, 983040
s_lshl_b32 s3, s27, 12
s_and_b32 s13, s2, 31
s_lshl_b32 s95, s13, 2
s_add_u32 s3, s3, s95
L_pad28:
s_cbranch_execz L_pad29
s_add_u32 s80, s3, 1015808
s_sub_u32 s100, s100, 1
s_cbranch_scc0 L_sk61
s_mov_b32 s100, 0
s_waitcnt vmcnt(4)
L_sk61:
buffer_load_dwordx4 v[140:143], v6, s[36:39], s4 offen offset:512 nt
v_lshlrev_b32 v231, 2, v4
v_lshlrev_b32 v232, 4, v3
v_lshl_add_u32 v232, v4, 2, v232
s_lshl_b32 s3, s28, 8
v_add_u32 v232, s3, v232
v_mov_b32 v233, s60
v_lshlrev_b32 v234, 7, v1
v_and_b32 v236, 7, v1
v_mul_u32_u24 v253, 896, v236
v_lshlrev_b32 v236, 4, v236
v_lshl_add_u32 v236, v4, 7, v236
s_lshl_b32 s3, s24, 4
s_lshl_b64 s[84:85], 0xffff, s3
s_not_b64 s[86:87], s[84:85]
s_waitcnt vmcnt(4)
v_perm_b32 v32, v100, v96, s64
v_perm_b32 v33, v108, v104, s64
v_perm_b32 v34, v116, v112, s64
v_mov_b32 v35, 0
v_perm_b32 v36, v100, v96, s65
v_perm_b32 v37, v108, v104, s65
v_perm_b32 v38, v116, v112, s65
v_mov_b32 v39, 0
v_mfma_f32_16x16x32_bf16 v[192:195], v[32:35], v[20:23], v[192:195]
L_pad29:
s_cbranch_execz L_pad30
v_perm_b32 v40, v101, v97, s64
v_perm_b32 v41, v109, v105, s64
v_perm_b32 v42, v117, v113, s64
v_mov_b32 v43, 0
v_mfma_f32_16x16x32_bf16 v[196:199], v[36:39], v[20:23], v[196:199]
v_perm_b32 v44, v101, v97, s65
v_perm_b32 v45, v109, v105, s65
v_perm_b32 v46, v117, v113, s65
v_mov_b32 v47, 0
v_mfma_f32_16x16x32_bf16 v[200:203], v[40:43], v[20:23], v[200:203]
v_perm_b32 v32, v102, v98, s64
v_perm_b32 v33, v110, v106, s64
v_perm_b32 v34, v118, v114, s64
v_mov_b32 v35, 0
v_mfma_f32_16x16x32_bf16 v[204:207], v[44:47], v[20:23], v[204:207]
v_perm_b32 v36, v102, v98, s65
v_perm_b32 v37, v110, v106, s65
v_perm_b32 v38, v118, v114, s65
v_mov_b32 v39, 0
v_mfma_f32_16x16x32_bf16 v[208:211], v[32:35], v[20:23], v[208:211]
v_perm_b32 v40, v103, v99, s64
v_perm_b32 v41, v111, v107, s64
v_perm_b32 v42, v119, v115, s64
v_mov_b32 v43, 0
v_mfma_f32_16x16x32_bf16 v[212:215], v[36:39], v[20:23], v[212:215]
v_perm_b32 v44, v103, v99, s65
v_perm_b32 v45, v111, v107, s65
v_perm_b32 v46, v119, v115, s65
v_mov_b32 v47, 0
v_mfma_f32_16x16x32_bf16 v[216:219], v[40:43], v[20:23], v[216:219]
L_pad30:
s_cbranch_execz L_pad31
s_nop 1
v_mfma_f32_16x16x32_bf16 v[220:223], v[44:47], v[20:23], v[220:223]
s_waitcnt vmcnt(13)
v_lshrrev_b32 v12, 2, v1
v_lshlrev_b32 v12, 7, v12
v_add_u32 v12, s7, v12
v_and_b32 v13, 3, v1
v_lshlrev_b32 v13, 1, v13
v_bfe_u32 v14, v1, 3, 1
v_xor_b32 v13, v13, v14
v_lshl_add_u32 v12, v13, 4, v12
v_xor_b32 v13, 16, v12
ds_read_b64_tr_b16 v[64:65], v12 offset:0
ds_read_b64_tr_b16 v[66:67], v12 offset:2048
ds_read_b64_tr_b16 v[68:69], v12 offset:8
ds_read_b64_tr_b16 v[70:71], v12 offset:2056
ds_read_b64_tr_b16 v[72:73], v13 offset:0
ds_read_b64_tr_b16 v[74:75], v13 offset:2048
ds_read_b64_tr_b16 v[76:77], v13 offset:8
ds_read_b64_tr_b16 v[78:79], v13 offset:2056
ds_read_b64_tr_b16 v[80:81], v12 offset:4096
ds_read_b64_tr_b16 v[82:83], v12 offset:6144
ds_read_b64_tr_b16 v[84:85], v12 offset:4104
ds_read_b64_tr_b16 v[86:87], v12 offset:6152
ds_read_b64_tr_b16 v[88:89], v13 offset:4096
ds_read_b64_tr_b16 v[90:91], v13 offset:6144
ds_read_b64_tr_b16 v[92:93], v13 offset:4104
ds_read_b64_tr_b16 v[94:95], v13 offset:6152
ds_read_b64_tr_b16 v[96:97], v12 offset:8192
ds_read_b64_tr_b16 v[98:99], v12 offset:10240
L_pad31:
s_cbranch_execz L_pad32
ds_read_b64_tr_b16 v[100:101], v12 offset:8200
ds_read_b64_tr_b16 v[102:103], v12 offset:10248
ds_read_b64_tr_b16 v[104:105], v13 offset:8192
ds_read_b64_tr_b16 v[106:107], v13 offset:10240
ds_read_b64_tr_b16 v[108:109], v13 offset:8200
ds_read_b64_tr_b16 v[110:111], v13 offset:10248
ds_read_b64_tr_b16 v[112:113], v12 offset:12288
ds_read_b64_tr_b16 v[114:115], v12 offset:14336
ds_read_b64_tr_b16 v[116:117], v12 offset:12296
ds_read_b64_tr_b16 v[118:119], v12 offset:14344
ds_read_b64_tr_b16 v[120:121], v13 offset:12288
ds_read_b64_tr_b16 v[122:123], v13 offset:14336
ds_read_b64_tr_b16 v[124:125], v13 offset:12296
ds_read_b64_tr_b16 v[126:127], v13 offset:14344
s_sub_u32 s100, s100, 1
s_cbranch_scc0 L_sk62
s_mov_b32 s100, 0
s_waitcnt vmcnt(4)
L_sk62:
s_xor_b32 s4, s73, 8192
buffer_load_dwordx4 v[144:147], v6, s[36:39], s4 offen offset:0 nt
s_lshr_b32 s3, s24, 1
s_lshl_b32 s3, s3, 3
s_lshr_b32 s82, 0xff00ff00, s3
s_lshr_b32 s3, s28, 2
s_xor_b32 s3, s3, s24
s_and_b32 s3, s3, 1
s_cmp_eq_u32 s3, 0
s_cselect_b32 s82, s82, -1
s_mov_b32 s83, s82
s_and_b32 s81, s82, 0x01010101
L_pad32:
s_cbranch_execz L_pad33
s_lshl_b32 s3, s2, 13
s_add_u32 s8, s3, 4194304
s_add_u32 s9, s8, 7168
s_mul_i32 s14, s27, 7168
s_sub_u32 s100, s100, 1
s_cbranch_scc0 L_sk63
s_mov_b32 s100, 0
s_waitcnt vmcnt(4)
L_sk63:
buffer_load_dwordx4 v[148:151], v6, s[36:39], s4 offen offset:512 nt
s_lshl_b32 s3, s13, 4
v_add_u32 v250, s3, v3
v_and_b32 v251, 0x1f8, v250
v_lshl_add_u32 v253, v251, 1, v253
v_lshl_add_u32 v253, v4, 2, v253
v_lshlrev_b32 v252, 13, v4
v_add_u32 v251, v251, v252
v_lshl_add_u32 v250, v250, 4, v252
v_lshlrev_b32 v252, 3, v0
s_lshl_b32 s3, s27, 5
s_lshl_b32 s95, s28, 2
s_add_u32 s3, s3, s95
s_lshl_b32 s10, s3, 13
s_add_u32 s10, s10, 4194304
s_add_u32 s11, s10, 7168
s_waitcnt vmcnt(4)
s_xor_b32 s4, s73, 12288
buffer_load_dwordx4 v[152:155], v6, s[36:39], s4 offen offset:0 nt
v_bfe_u32 v254, v1, 4, 1
v_lshlrev_b32 v254, 1, v254
v_and_b32 v237, 7, v1
L_pad33:
s_cbranch_execz L_chainback
v_xor_b32 v254, v254, v237
s_and_b32 s3, s28, 1
s_lshl_b32 s3, s3, 2
v_xor_b32 v254, s3, v254
v_lshlrev_b32 v254, 4, v254
v_lshrrev_b32 v237, 3, v1
v_lshl_add_u32 v254, v237, 9, v254
s_waitcnt vmcnt(4)
buffer_load_dwordx4 v[156:159], v6, s[36:39], s4 offen offset:512 nt
v_bfe_u32 v5, v1, 3, 1
v_bfe_u32 v9, v1, 1, 1
s_and_b32 s3, s28, 1
s_lshl_b32 s3, s3, 2
v_or_b32 v9, s3, v9
v_bfe_u32 v237, v1, 4, 1
v_lshlrev_b32 v237, 1, v237
v_xor_b32 v9, v9, v237
v_lshlrev_b32 v237, 2, v5
v_xor_b32 v9, v9, v237
v_lshlrev_b32 v9, 4, v9
v_and_b32 v237, 1, v1
v_lshl_or_b32 v9, v237, 3, v9
v_lshl_add_u32 v9, v4, 8, v9
v_bfe_u32 v237, v1, 2, 1
v_lshl_add_u32 v9, v237, 7, v9
s_lshl_b32 s3, s94, 9
s_add_u32 s3, s3, 40960
v_add_u32 v9, s3, v9
v_add_u32 v237, 1, v5
v_and_b32 v237, 7, v237
L_seg5:
L_pad34:
s_cbranch_execz L_pad35
v_lshl_add_u32 v238, v237, 14, v9
v_add_u32 v237, 3, v5
v_and_b32 v237, 7, v237
v_lshl_add_u32 v239, v237, 14, v9
v_add_u32 v237, 5, v5
v_and_b32 v237, 7, v237
v_lshl_add_u32 v62, v237, 14, v9
v_add_u32 v237, 7, v5
v_and_b32 v237, 7, v237
v_lshl_add_u32 v63, v237, 14, v9
s_waitcnt vmcnt(4)
s_xor_b32 s4, s73, 16384
buffer_load_dwordx4 v[160:163], v6, s[36:39], s4 offen offset:0 nt
s_waitcnt vmcnt(4)
buffer_load_dwordx4 v[164:167], v6, s[36:39], s4 offen offset:512 nt
s_cmp_lg_u32 s28, 3
s_cbranch_scc1 L_o64
buffer_load_dwordx4 v[56:59], v11, s[52:55], s71 offen sc1
L_o64:
s_waitcnt vmcnt(4)
s_xor_b32 s4, s73, 20480
buffer_load_dwordx4 v[168:171], v6, s[36:39], s4 offen offset:0 nt
s_waitcnt vmcnt(4)
buffer_load_dwordx4 v[172:175], v6, s[36:39], s4 offen offset:512 nt
s_waitcnt vmcnt(4)
v_perm_b32 v32, v132, v128, s64
v_perm_b32 v33, v140, v136, s64
v_perm_b32 v34, v148, v144, s64
v_perm_b32 v35, v156, v152, s64
v_perm_b32 v36, v132, v128, s65
v_perm_b32 v37, v140, v136, s65
L_pad35:
s_cbranch_execz L_pad36
v_perm_b32 v38, v148, v144, s65
v_perm_b32 v39, v156, v152, s65
v_mfma_f32_16x16x32_bf16 v[192:195], v[32:35], v[24:27], v[192:195]
v_perm_b32 v40, v133, v129, s64
v_perm_b32 v41, v141, v137, s64
v_perm_b32 v42, v149, v145, s64
v_perm_b32 v43, v157, v153, s64
v_mfma_f32_16x16x32_bf16 v[196:199], v[36:39], v[24:27], v[196:199]
v_perm_b32 v44, v133, v129, s65
v_perm_b32 v45, v141, v137, s65
v_perm_b32 v46, v149, v145, s65
v_perm_b32 v47, v157, v153, s65
v_mfma_f32_16x16x32_bf16 v[200:203], v[40:43], v[24:27], v[200:203]
v_perm_b32 v32, v134, v130, s64
v_perm_b32 v33, v142, v138, s64
v_perm_b32 v34, v150, v146, s64
v_perm_b32 v35, v158, v154, s64
v_mfma_f32_16x16x32_bf16 v[204:207], v[44:47], v[24:27], v[204:207]
v_perm_b32 v36, v134, v130, s65
v_perm_b32 v37, v142, v138, s65
v_perm_b32 v38, v150, v146, s65
v_perm_b32 v39, v158, v154, s65
v_mfma_f32_16x16x32_bf16 v[208:211], v[32:35], v[24:27], v[208:211]
v_perm_b32 v40, v135, v131, s64
v_perm_b32 v41, v143, v139, s64
v_perm_b32 v42, v151, v147, s64
v_perm_b32 v43, v159, v155, s64
v_mfma_f32_16x16x32_bf16 v[212:215], v[36:39], v[24:27], v[212:215]
v_perm_b32 v44, v135, v131, s65
v_perm_b32 v45, v143, v139, s65
L_pad36:
s_cbranch_execz L_pad37
v_perm_b32 v46, v151, v147, s65
v_perm_b32 v47, v159, v155, s65
v_mfma_f32_16x16x32_bf16 v[216:219], v[40:43], v[24:27], v[216:219]
s_nop 1
v_mfma_f32_16x16x32_bf16 v[220:223], v[44:47], v[24:27], v[220:223]
s_waitcnt vmcnt(4)
s_xor_b32 s4, s73, 24576
buffer_load_dwordx4 v[176:179], v6, s[36:39], s4 offen offset:0 nt
s_waitcnt vmcnt(4)
buffer_load_dwordx4 v[180:183], v6, s[36:39], s4 offen offset:512 nt
s_waitcnt lgkmcnt(0)
s_barrier
s_add_u32 m0, s7, 8192
s_xor_b32 s4, s90, 28672
buffer_load_dwordx4 v254, s[36:39], s4 offen nt lds
s_add_u32 m0, s7, 9216
s_xor_b32 s4, s90, 28800
buffer_load_dwordx4 v254, s[36:39], s4 offen nt lds
s_add_u32 m0, s7, 10240
s_xor_b32 s4, s90, 28928
buffer_load_dwordx4 v254, s[36:39], s4 offen nt lds
s_add_u32 m0, s7, 11264
s_xor_b32 s4, s90, 29056
buffer_load_dwordx4 v254, s[36:39], s4 offen nt lds
s_cmp_eq_u32 s98, 1
s_cselect_b64 exec, s[86:87], s[84:85]
buffer_load_dword v249, v229, s[52:55], s74 offen sc1
s_mov_b64 exec, -1
s_cmp_eq_u32 s98, 1
s_cselect_b64 exec, s[86:87], s[84:85]
L_pad37:
s_cbranch_execz L_pad38
buffer_load_dword v249, v230, s[52:55], s75 offen sc1
s_mov_b64 exec, -1
v_xor_b32 v12, 32, v238
v_xor_b32 v13, 32, v239
v_xor_b32 v14, 32, v62
v_xor_b32 v15, 32, v63
ds_read_b128 v[16:19], v11 offset:18432
ds_read_b128 v[20:23], v11 offset:19456
s_cmp_lg_u32 s28, 3
s_cbranch_scc1 L_noml
s_mov_b32 s69, 65536
s_waitcnt vmcnt(9)
L_mchk:
v_dot2_u32_u16 v60, v56, v48, s60
v_dot2_u32_u16 v61, v56, v52, s61
v_dot2_u32_u16 v60, v57, v49, v60
v_dot2_u32_u16 v61, v57, v53, v61
s_nop 2
v_cmp_ne_u64 vcc, v[58:59], v[60:61]
s_cbranch_vccz L_mok
s_sub_u32 s69, s69, 1
s_cbranch_scc1 L_mok
s_mov_b64 exec, vcc
s_sleep 8
buffer_load_dwordx4 v[56:59], v11, s[52:55], s71 offen sc1
s_waitcnt vmcnt(0)
s_branch L_mchk
L_mok:
s_mov_b64 exec, -1
v_mov_b32 v58, v56
v_mov_b32 v59, v58
s_nop 1
L_pad38:
s_cbranch_execz L_pad39
v_permlane16_swap_b32 v58, v59
s_nop 0
v_max_f32 v58, v58, v59
v_mov_b32 v59, v58
s_nop 1
v_permlane32_swap_b32 v58, v59
s_nop 0
v_max_f32 v58, v58, v59
v_sub_f32 v56, v56, v58
v_sub_f32 v60, v8, v58
v_mul_f32 v56, s66, v56
v_mul_f32 v60, s66, v60
v_exp_f32 v56, v56
v_exp_f32 v60, v60
s_nop 0
v_mul_f32 v57, v57, v56
v_mov_b32 v59, v57
s_nop 1
v_permlane16_swap_b32 v57, v59
s_nop 0
v_add_f32 v57, v57, v59
v_mov_b32 v59, v57
s_nop 1
v_permlane32_swap_b32 v57, v59
s_nop 0
v_add_f32 v57, v57, v59
v_rcp_f32 v57, v57
s_nop 0
v_mul_f32 v60, v60, v57
v_mov_b32 v61, v60
L_pad39:
s_cbranch_execz L_pad40
ds_write_b64 v11, v[60:61] offset:21504
L_noml:
v_mov_b32 v131, 0
v_mov_b32 v135, 0
v_mov_b32 v139, 0
v_mov_b32 v143, 0
v_mov_b32 v147, 0
v_mov_b32 v151, 0
v_mov_b32 v155, 0
v_mov_b32 v159, 0
s_waitcnt vmcnt(8)
v_perm_b32 v128, v164, v160, s64
v_perm_b32 v132, v164, v160, s65
v_perm_b32 v136, v165, v161, s64
v_perm_b32 v140, v165, v161, s65
v_perm_b32 v144, v166, v162, s64
v_perm_b32 v148, v166, v162, s65
v_perm_b32 v152, v167, v163, s64
v_perm_b32 v156, v167, v163, s65
v_perm_b32 v129, v172, v168, s64
v_perm_b32 v133, v172, v168, s65
v_perm_b32 v137, v173, v169, s64
v_perm_b32 v141, v173, v169, s65
v_perm_b32 v145, v174, v170, s64
v_perm_b32 v149, v174, v170, s65
v_perm_b32 v153, v175, v171, s64
v_perm_b32 v157, v175, v171, s65
s_waitcnt vmcnt(6)
v_perm_b32 v130, v180, v176, s64
v_perm_b32 v134, v180, v176, s65
v_perm_b32 v138, v181, v177, s64
L_pad40:
s_cbranch_execz L_chainback
v_perm_b32 v142, v181, v177, s65
v_perm_b32 v146, v182, v178, s64
v_perm_b32 v150, v182, v178, s65
v_perm_b32 v154, v183, v179, s64
v_perm_b32 v158, v183, v179, s65
v_mfma_f32_16x16x32_bf16 v[192:195], v[128:131], v[28:31], v[192:195]
v_mfma_f32_16x16x32_bf16 v[196:199], v[132:135], v[28:31], v[196:199]
v_mfma_f32_16x16x32_bf16 v[200:203], v[136:139], v[28:31], v[200:203]
v_mfma_f32_16x16x32_bf16 v[204:207], v[140:143], v[28:31], v[204:207]
v_mfma_f32_16x16x32_bf16 v[208:211], v[144:147], v[28:31], v[208:211]
v_mfma_f32_16x16x32_bf16 v[212:215], v[148:151], v[28:31], v[212:215]
v_mfma_f32_16x16x32_bf16 v[216:219], v[152:155], v[28:31], v[216:219]
v_mfma_f32_16x16x32_bf16 v[220:223], v[156:159], v[28:31], v[220:223]
s_nop 0
v_mov_b32 v160, v192
v_mov_b32 v168, v193
v_mov_b32 v176, v194
v_mov_b32 v184, v195
v_mov_b32 v161, v196
v_mov_b32 v169, v197
v_mov_b32 v177, v198
v_mov_b32 v185, v199
v_mov_b32 v162, v200
v_mov_b32 v170, v201
v_mov_b32 v178, v202
v_mov_b32 v186, v203
v_mov_b32 v163, v204
v_mov_b32 v171, v205
v_mov_b32 v179, v206
v_mov_b32 v187, v207
L_seg6:
L_pad41:
s_cbranch_execz L_pad42
v_mov_b32 v164, v208
v_mov_b32 v172, v209
v_mov_b32 v180, v210
v_mov_b32 v188, v211
v_mov_b32 v165, v212
v_mov_b32 v173, v213
v_mov_b32 v181, v214
v_mov_b32 v189, v215
v_mov_b32 v166, v216
v_mov_b32 v174, v217
v_mov_b32 v182, v218
v_mov_b32 v190, v219
v_mov_b32 v167, v220
v_mov_b32 v175, v221
v_mov_b32 v183, v222
v_mov_b32 v191, v223
ds_write_b128 v224, v[160:163] offset:0
ds_write_b128 v224, v[164:167] offset:1024
ds_write_b128 v224, v[168:171] offset:2048
ds_write_b128 v224, v[172:175] offset:3072
ds_write_b128 v224, v[176:179] offset:4096
ds_write_b128 v224, v[180:183] offset:5120
ds_write_b128 v224, v[184:187] offset:6144
ds_write_b128 v224, v[188:191] offset:7168
s_waitcnt lgkmcnt(0)
s_barrier
ds_read_b64 v[60:61], v11 offset:21504
ds_read_b128 v[128:131], v225 offset:0
ds_read_b128 v[132:135], v225 offset:4096
ds_read_b128 v[136:139], v225 offset:32768
L_pad42:
s_cbranch_execz L_pad43
ds_read_b128 v[140:143], v225 offset:36864
ds_read_b128 v[144:147], v226 offset:0
ds_read_b128 v[148:151], v226 offset:4096
ds_read_b128 v[152:155], v226 offset:32768
ds_read_b128 v[156:159], v226 offset:36864
s_waitcnt lgkmcnt(4)
v_pk_add_f32 v[128:129], v[128:129], v[136:137]
v_pk_add_f32 v[130:131], v[130:131], v[138:139]
v_pk_add_f32 v[132:133], v[132:133], v[140:141]
v_pk_add_f32 v[134:135], v[134:135], v[142:143]
s_waitcnt lgkmcnt(2)
v_pk_add_f32 v[128:129], v[128:129], v[144:145]
v_pk_add_f32 v[130:131], v[130:131], v[146:147]
v_pk_add_f32 v[132:133], v[132:133], v[148:149]
v_pk_add_f32 v[134:135], v[134:135], v[150:151]
s_waitcnt lgkmcnt(0)
v_pk_add_f32 v[128:129], v[128:129], v[152:153]
v_pk_add_f32 v[130:131], v[130:131], v[154:155]
v_pk_add_f32 v[132:133], v[132:133], v[156:157]
v_pk_add_f32 v[134:135], v[134:135], v[158:159]
s_waitcnt vmcnt(2)
s_barrier
ds_read_b64_tr_b16 v[192:193], v238
ds_read_b64_tr_b16 v[194:195], v239
ds_read_b64_tr_b16 v[196:197], v12
ds_read_b64_tr_b16 v[198:199], v13
ds_read_b64_tr_b16 v[200:201], v62
ds_read_b64_tr_b16 v[202:203], v63
ds_read_b64_tr_b16 v[204:205], v14
ds_read_b64_tr_b16 v[206:207], v15
L_pad43:
s_cbranch_execz L_pad44
s_cmp_eq_u32 s98, 1
s_cbranch_scc0 L_slow5
L_back5:
s_waitcnt lgkmcnt(4)
v_mfma_f32_16x16x32_bf16 v[128:131], v[192:195], v[16:19], v[128:131]
v_mfma_f32_16x16x32_bf16 v[132:135], v[196:199], v[16:19], v[132:135]
s_waitcnt lgkmcnt(0)
v_mfma_f32_16x16x32_bf16 v[128:131], v[200:203], v[20:23], v[128:131]
v_mfma_f32_16x16x32_bf16 v[132:135], v[204:207], v[20:23], v[132:135]
s_nop 6
v_pk_mul_f32 v[128:129], v[128:129], v[60:61]
v_pk_mul_f32 v[130:131], v[130:131], v[60:61]
v_pk_mul_f32 v[132:133], v[132:133], v[60:61]
v_pk_mul_f32 v[134:135], v[134:135], v[60:61]
v_cvt_pk_bf16_f32 v136, v128, v129
v_cvt_pk_bf16_f32 v137, v130, v131
v_cvt_pk_bf16_f32 v138, v132, v133
v_cvt_pk_bf16_f32 v139, v134, v135
s_mov_b64 exec, s[82:83]
s_cbranch_scc0 L_os1
buffer_store_dwordx4 v[136:139], v227, s[52:55], s67 offen
L_os2:
s_mov_b64 exec, -1
ds_write_b128 v227, v[136:139] offset:0
v_dot2_u32_u16 v140, v136, v48, 0
v_dot2_u32_u16 v141, v136, v52, 0
v_dot2_u32_u16 v140, v137, v49, v140
v_dot2_u32_u16 v141, v137, v53, v141
v_dot2_u32_u16 v140, v138, v50, v140
v_dot2_u32_u16 v141, v138, v54, v141
v_dot2_u32_u16 v140, v139, v51, v140
v_dot2_u32_u16 v141, v139, v55, v141
L_pad44:
s_cbranch_execz L_pad45
s_nop 2
v_add_u32_dpp v140, v140, v140 quad_perm:[1,0,3,2] row_mask:0xf bank_mask:0xf
v_add_u32_dpp v141, v141, v141 quad_perm:[1,0,3,2] row_mask:0xf bank_mask:0xf
s_nop 0
v_add_u32_dpp v140, v140, v140 quad_perm:[2,3,0,1] row_mask:0xf bank_mask:0xf
v_add_u32_dpp v141, v141, v141 quad_perm:[2,3,0,1] row_mask:0xf bank_mask:0xf
s_nop 0
v_add_u32_dpp v140, v140, v140 row_half_mirror row_mask:0xf bank_mask:0xf
v_add_u32_dpp v141, v141, v141 row_half_mirror row_mask:0xf bank_mask:0xf
v_add_u32 v140, s60, v140
v_add_u32 v141, s61, v141
s_mov_b32 exec_lo, s81
s_mov_b32 exec_hi, s81
s_cbranch_scc0 L_os3
buffer_store_dwordx2 v[140:141], v228, s[52:55], s68 offen
L_os4:
s_waitcnt lgkmcnt(0)
s_barrier
s_mov_b64 exec, s[84:85]
ds_read_b128 v[240:243], v235 offset:0
s_mov_b32 s69, 65536
s_mov_b64 exec, s[86:87]
s_cmp_eq_u32 s98, 1
s_cbranch_scc1 L_ogd
s_waitcnt vmcnt(2)
L_ogh:
v_cmp_ne_u32 vcc, s60, v248
s_cbranch_vccz L_ogd
s_sub_u32 s69, s69, 1
s_cbranch_scc1 L_ogok
s_sleep 1
buffer_load_dword v248, v231, s[52:55], s76 offen sc1
L_pad45:
s_cbranch_execz L_pad46
s_waitcnt vmcnt(0)
s_branch L_ogh
L_ogd:
s_mov_b64 exec, s[86:87]
buffer_load_dwordx4 v[240:243], v229, s[52:55], s74 offen sc1
buffer_load_dwordx2 v[244:245], v230, s[52:55], s75 offen sc1
s_sub_u32 s69, s69, 1
s_cbranch_scc1 L_ogok
s_waitcnt vmcnt(1)
v_dot2_u32_u16 v246, v240, v48, 0
v_dot2_u32_u16 v247, v240, v52, 0
v_dot2_u32_u16 v246, v241, v49, v246
v_dot2_u32_u16 v247, v241, v53, v247
v_dot2_u32_u16 v246, v242, v50, v246
v_dot2_u32_u16 v247, v242, v54, v247
v_dot2_u32_u16 v246, v243, v51, v246
v_dot2_u32_u16 v247, v243, v55, v247
s_nop 2
v_add_u32_dpp v246, v246, v246 quad_perm:[1,0,3,2] row_mask:0xf bank_mask:0xf
v_add_u32_dpp v247, v247, v247 quad_perm:[1,0,3,2] row_mask:0xf bank_mask:0xf
s_nop 0
v_add_u32_dpp v246, v246, v246 quad_perm:[2,3,0,1] row_mask:0xf bank_mask:0xf
v_add_u32_dpp v247, v247, v247 quad_perm:[2,3,0,1] row_mask:0xf bank_mask:0xf
s_nop 0
v_add_u32_dpp v246, v246, v246 row_half_mirror row_mask:0xf bank_mask:0xf
v_add_u32_dpp v247, v247, v247 row_half_mirror row_mask:0xf bank_mask:0xf
v_add_u32 v246, s60, v246
v_add_u32 v247, s61, v247
s_waitcnt vmcnt(0)
v_cmp_eq_u64 vcc, v[244:245], v[246:247]
s_andn2_b64 s[86:87], s[86:87], vcc
L_pad46:
s_cbranch_execz L_pad47
s_cbranch_scc1 L_ogd
L_ogok:
s_mov_b64 exec, -1
s_waitcnt lgkmcnt(0)
v_permlane32_swap_b32 v240, v242
v_permlane32_swap_b32 v241, v243
s_nop 1
v_permlane16_swap_b32 v240, v241
v_permlane16_swap_b32 v242, v243
s_nop 0
v_lshlrev_b32 v152, 16, v240
v_and_b32 v153, 0xffff0000, v240
v_lshlrev_b32 v154, 16, v241
v_and_b32 v155, 0xffff0000, v241
v_lshlrev_b32 v156, 16, v242
v_and_b32 v157, 0xffff0000, v242
v_lshlrev_b32 v158, 16, v243
v_and_b32 v159, 0xffff0000, v243
v_pk_add_f32 v[152:153], v[152:153], v[154:155]
v_pk_add_f32 v[156:157], v[156:157], v[158:159]
v_pk_add_f32 v[152:153], v[152:153], v[156:157]
v_cvt_pk_bf16_f32 v152, v152, v153
ds_write_b32 v232, v152 offset:16384
s_mov_b64 s[86:87], -1
v_cmp_lt_u32 vcc, 7, v3
s_cmp_lg_u32 s28, 7
s_waitcnt lgkmcnt(0)
s_barrier
s_cbranch_scc1 L_proj
s_mov_b64 exec, 0x0fffffff
buffer_store_dword v233, v234, s[52:55], s80 offen sc1
L_pad47:
s_cbranch_execz L_chainback
s_mov_b64 exec, -1
v_mov_b32 v248, 0
s_branch L_ypubdone
L_proj:
ds_read_b128 v[16:19], v236 offset:16384
ds_read_b128 v[20:23], v236 offset:16896
ds_read_b128 v[24:27], v236 offset:17408
ds_read_b128 v[28:31], v236 offset:17920
s_waitcnt lgkmcnt(3)
v_mfma_f32_16x16x32_bf16 v[128:131], v[64:67], v[16:19], 0
v_mfma_f32_16x16x32_bf16 v[132:135], v[68:71], v[16:19], 0
v_mfma_f32_16x16x32_bf16 v[136:139], v[72:75], v[16:19], 0
v_mfma_f32_16x16x32_bf16 v[140:143], v[76:79], v[16:19], 0
s_waitcnt lgkmcnt(2)
v_mfma_f32_16x16x32_bf16 v[128:131], v[80:83], v[20:23], v[128:131]
v_mfma_f32_16x16x32_bf16 v[132:135], v[84:87], v[20:23], v[132:135]
v_mfma_f32_16x16x32_bf16 v[136:139], v[88:91], v[20:23], v[136:139]
v_mfma_f32_16x16x32_bf16 v[140:143], v[92:95], v[20:23], v[140:143]
s_waitcnt lgkmcnt(1)
v_mfma_f32_16x16x32_bf16 v[128:131], v[96:99], v[24:27], v[128:131]
v_mfma_f32_16x16x32_bf16 v[132:135], v[100:103], v[24:27], v[132:135]
v_mfma_f32_16x16x32_bf16 v[136:139], v[104:107], v[24:27], v[136:139]
v_mfma_f32_16x16x32_bf16 v[140:143], v[108:111], v[24:27], v[140:143]
s_waitcnt lgkmcnt(0)
v_mfma_f32_16x16x32_bf16 v[128:131], v[112:115], v[28:31], v[128:131]
v_mfma_f32_16x16x32_bf16 v[132:135], v[116:119], v[28:31], v[132:135]
v_mfma_f32_16x16x32_bf16 v[136:139], v[120:123], v[28:31], v[136:139]
v_mfma_f32_16x16x32_bf16 v[140:143], v[124:127], v[28:31], v[140:143]
buffer_load_dword v248, v231, s[52:55], s12 offen sc1
s_nop 4
v_cvt_pk_bf16_f32 v144, v128, v129
L_seg7:
L_pad48:
s_cbranch_execz L_pad49
v_cvt_pk_bf16_f32 v145, v130, v131
v_cvt_pk_bf16_f32 v146, v132, v133
v_cvt_pk_bf16_f32 v147, v134, v135
v_cvt_pk_bf16_f32 v148, v136, v137
v_cvt_pk_bf16_f32 v149, v138, v139
v_cvt_pk_bf16_f32 v150, v140, v141
v_cvt_pk_bf16_f32 v151, v142, v143
v_cndmask_b32 v136, v144, v148, vcc
v_cndmask_b32 v137, v145, v149, vcc
v_cndmask_b32 v138, v146, v150, vcc
v_cndmask_b32 v139, v147, v151, vcc
buffer_store_dwordx4 v[136:139], v227, s[52:55], s8 offen sc1
v_dot2_u32_u16 v140, v136, v48, 0
v_dot2_u32_u16 v141, v136, v52, 0
v_dot2_u32_u16 v140, v137, v49, v140
v_dot2_u32_u16 v141, v137, v53, v141
v_dot2_u32_u16 v140, v138, v50, v140
v_dot2_u32_u16 v141, v138, v54, v141
v_dot2_u32_u16 v140, v139, v51, v140
v_dot2_u32_u16 v141, v139, v55, v141
s_nop 2
v_add_u32_dpp v140, v140, v140 quad_perm:[1,0,3,2] row_mask:0xf bank_mask:0xf
v_add_u32_dpp v141, v141, v141 quad_perm:[1,0,3,2] row_mask:0xf bank_mask:0xf
s_nop 0
v_add_u32_dpp v140, v140, v140 quad_perm:[2,3,0,1] row_mask:0xf bank_mask:0xf
v_add_u32_dpp v141, v141, v141 quad_perm:[2,3,0,1] row_mask:0xf bank_mask:0xf
s_nop 0
v_add_u32_dpp v140, v140, v140 row_half_mirror row_mask:0xf bank_mask:0xf
v_add_u32_dpp v141, v141, v141 row_half_mirror row_mask:0xf bank_mask:0xf
v_add_u32 v140, s60, v140
L_pad49:
s_cbranch_execz L_pad50
v_add_u32 v141, s61, v141
s_mov_b32 exec_lo, 0x01010101
s_mov_b32 exec_hi, 0x01010101
buffer_store_dwordx2 v[140:141], v228, s[52:55], s9 offen sc1
L_ypubdone:
s_cmp_ge_u32 s13, 28
s_cbranch_scc1 L_fin
s_mov_b32 s69, 65536
s_mov_b64 exec, s[86:87]
s_waitcnt vmcnt(2)
L_ygh:
v_cmp_ne_u32 vcc, s60, v248
s_cbranch_vccz L_ygd
s_sub_u32 s69, s69, 1
s_cbranch_scc1 L_ygok
s_sleep 1
buffer_load_dword v248, v231, s[52:55], s12 offen sc1
s_waitcnt vmcnt(0)
s_branch L_ygh
L_ygd:
s_mov_b64 exec, s[86:87]
buffer_load_dwordx4 v[240:243], v250, s[52:55], s10 offen sc1
buffer_load_dwordx2 v[244:245], v251, s[52:55], s11 offen sc1
s_sub_u32 s69, s69, 1
s_cbranch_scc1 L_ygok
s_waitcnt vmcnt(1)
v_dot2_u32_u16 v246, v240, v48, 0
v_dot2_u32_u16 v247, v240, v52, 0
v_dot2_u32_u16 v246, v241, v49, v246
v_dot2_u32_u16 v247, v241, v53, v247
v_dot2_u32_u16 v246, v242, v50, v246
v_dot2_u32_u16 v247, v242, v54, v247
v_dot2_u32_u16 v246, v243, v51, v246
L_pad50:
s_cbranch_execz L_pad51
v_dot2_u32_u16 v247, v243, v55, v247
s_nop 2
v_add_u32_dpp v246, v246, v246 quad_perm:[1,0,3,2] row_mask:0xf bank_mask:0xf
v_add_u32_dpp v247, v247, v247 quad_perm:[1,0,3,2] row_mask:0xf bank_mask:0xf
s_nop 0
v_add_u32_dpp v246, v246, v246 quad_perm:[2,3,0,1] row_mask:0xf bank_mask:0xf
v_add_u32_dpp v247, v247, v247 quad_perm:[2,3,0,1] row_mask:0xf bank_mask:0xf
s_nop 0
v_add_u32_dpp v246, v246, v246 row_half_mirror row_mask:0xf bank_mask:0xf
v_add_u32_dpp v247, v247, v247 row_half_mirror row_mask:0xf bank_mask:0xf
v_add_u32 v246, s60, v246
v_add_u32 v247, s61, v247
s_waitcnt vmcnt(0)
v_cmp_eq_u64 vcc, v[244:245], v[246:247]
s_andn2_b64 s[86:87], s[86:87], vcc
s_cbranch_scc1 L_ygd
L_ygok:
s_mov_b64 exec, -1
s_nop 0
v_permlane32_swap_b32 v240, v242
v_permlane32_swap_b32 v241, v243
s_nop 1
v_permlane16_swap_b32 v240, v241
v_permlane16_swap_b32 v242, v243
s_nop 0
v_lshlrev_b32 v152, 16, v240
v_and_b32 v153, 0xffff0000, v240
v_lshlrev_b32 v154, 16, v241
v_and_b32 v155, 0xffff0000, v241
v_lshlrev_b32 v156, 16, v242
v_and_b32 v157, 0xffff0000, v242
L_pad51:
s_cbranch_execz L_pad52
v_lshlrev_b32 v158, 16, v243
v_and_b32 v159, 0xffff0000, v243
v_pk_add_f32 v[152:153], v[152:153], v[154:155]
v_pk_add_f32 v[156:157], v[156:157], v[158:159]
v_pk_add_f32 v[152:153], v[152:153], v[156:157]
ds_write_b64 v252, v[152:153] offset:24576
s_cmp_lg_u32 s28, 0
s_waitcnt lgkmcnt(0)
s_barrier
s_cbranch_scc1 L_fin
ds_read_b64 v[154:155], v252 offset:25088
ds_read_b64 v[156:157], v252 offset:25600
ds_read_b64 v[158:159], v252 offset:26112
ds_read_b64 v[160:161], v252 offset:26624
ds_read_b64 v[162:163], v252 offset:27136
ds_read_b64 v[164:165], v252 offset:27648
ds_read_b64 v[166:167], v252 offset:28160
s_waitcnt lgkmcnt(0)
v_pk_add_f32 v[152:153], v[152:153], v[154:155]
v_pk_add_f32 v[156:157], v[156:157], v[158:159]
v_pk_add_f32 v[160:161], v[160:161], v[162:163]
v_pk_add_f32 v[164:165], v[164:165], v[166:167]
v_pk_add_f32 v[152:153], v[152:153], v[156:157]
v_pk_add_f32 v[160:161], v[160:161], v[164:165]
v_pk_add_f32 v[152:153], v[152:153], v[160:161]
v_cvt_pk_bf16_f32 v152, v152, v153
buffer_store_dword v152, v253, s[56:59], s14 offen
s_and_b32 s3, s2, 63
s_cmp_lg_u32 s3, 0
s_cbranch_scc1 L_fin
L_pad52:
s_cbranch_execz L_pad53
s_lshl_b32 s3, s63, 7
v_mov_b32 v12, s3
v_mov_b32 v13, s62
s_mov_b64 exec, 1
buffer_store_dword v13, v12, s[52:55], 0 offen sc1
L_fin:
s_endpgm
L_slow5:
s_cmp_lg_u32 s28, 0
s_cbranch_scc1 L_o65
s_mov_b64 exec, 15
buffer_store_dword v233, v234, s[52:55], s78 offen sc1
s_mov_b64 exec, -1
L_o65:
buffer_load_dword v248, v231, s[52:55], s76 offen sc1
s_cmp_eq_u32 s98, 1
s_branch L_back5
L_os1:
buffer_store_dwordx4 v[136:139], v227, s[52:55], s67 offen sc1
s_branch L_os2
L_os3:
buffer_store_dwordx2 v[140:141], v228, s[52:55], s68 offen sc1
s_branch L_os4
L_dburst:
s_barrier
s_add_u32 s100, s100, 5
s_cmp_eq_u32 s28, 7
s_cbranch_scc1 L_dret
s_setprio 2
s_add_u32 m0, s7, 0
s_add_u32 s3, s70, 0
buffer_load_dwordx4 v2, s[48:51], s3 offen lds
s_add_u32 m0, s7, 1024
s_add_u32 s3, s70, 7168
buffer_load_dwordx4 v2, s[48:51], s3 offen lds
s_add_u32 m0, s7, 2048
L_pad53:
s_cbranch_execz L_pad54
s_add_u32 s3, s70, 14336
buffer_load_dwordx4 v2, s[48:51], s3 offen lds
s_add_u32 m0, s7, 3072
s_add_u32 s3, s70, 21504
buffer_load_dwordx4 v2, s[48:51], s3 offen lds
s_add_u32 m0, s7, 4096
s_add_u32 s3, s70, 28672
buffer_load_dwordx4 v2, s[48:51], s3 offen lds
s_add_u32 m0, s7, 5120
s_add_u32 s3, s70, 35840
buffer_load_dwordx4 v2, s[48:51], s3 offen lds
s_add_u32 m0, s7, 6144
s_add_u32 s3, s70, 43008
buffer_load_dwordx4 v2, s[48:51], s3 offen lds
s_add_u32 m0, s7, 7168
s_add_u32 s3, s70, 50176
buffer_load_dwordx4 v2, s[48:51], s3 offen lds
s_add_u32 m0, s7, 8192
s_add_u32 s3, s70, 57344
buffer_load_dwordx4 v2, s[48:51], s3 offen lds
s_add_u32 m0, s7, 9216
s_add_u32 s3, s70, 64512
buffer_load_dwordx4 v2, s[48:51], s3 offen lds
s_add_u32 m0, s7, 10240
s_add_u32 s3, s70, 71680
buffer_load_dwordx4 v2, s[48:51], s3 offen lds
s_add_u32 m0, s7, 11264
s_add_u32 s3, s70, 78848
buffer_load_dwordx4 v2, s[48:51], s3 offen lds
s_add_u32 m0, s7, 12288
L_pad54:
s_cbranch_execz L_chainback
s_add_u32 s3, s70, 86016
buffer_load_dwordx4 v2, s[48:51], s3 offen lds
s_add_u32 m0, s7, 13312
s_add_u32 s3, s70, 93184
buffer_load_dwordx4 v2, s[48:51], s3 offen lds
s_add_u32 m0, s7, 14336
s_add_u32 s3, s70, 100352
buffer_load_dwordx4 v2, s[48:51], s3 offen lds
s_add_u32 m0, s7, 15360
s_add_u32 s3, s70, 107520
buffer_load_dwordx4 v2, s[48:51], s3 offen lds
s_setprio 0
L_dret:
s_barrier
s_setpc_b64 s[92:93]
L_wburst:
s_barrier
s_add_u32 s100, s100, 5
s_cmp_eq_u32 s28, 7
s_cbranch_scc1 L_wret
s_setprio 2
buffer_load_dwordx4 v[96:99], v9, s[44:47], s88 offen offset:0
buffer_load_dwordx4 v[100:103], v9, s[44:47], s88 offen offset:64
s_add_u32 m0, s7, 0
s_add_u32 s3, s31, 0
buffer_load_dwordx4 v8, s[40:43], s3 offen lds
s_add_u32 m0, s7, 1024
s_add_u32 s3, s31, 65536
buffer_load_dwordx4 v8, s[40:43], s3 offen lds
s_add_u32 m0, s7, 2048
s_add_u32 s3, s31, 131072
buffer_load_dwordx4 v8, s[40:43], s3 offen lds
s_add_u32 m0, s7, 3072
s_add_u32 s3, s31, 196608
buffer_load_dwordx4 v8, s[40:43], s3 offen lds
s_add_u32 m0, s7, 4096
s_add_u32 s3, s31, 262144
buffer_load_dwordx4 v8, s[40:43], s3 offen lds
s_add_u32 m0, s7, 5120
s_add_u32 s3, s31, 327680
buffer_load_dwordx4 v8, s[40:43], s3 offen lds
s_add_u32 m0, s7, 6144
s_add_u32 s3, s31, 393216
buffer_load_dwordx4 v8, s[40:43], s3 offen lds
s_add_u32 m0, s7, 7168
s_add_u32 s3, s31, 458752
buffer_load_dwordx4 v8, s[40:43], s3 offen lds
s_setprio 0
L_wret:
s_barrier
s_setpc_b64 s[92:93]
L_end:
s_endpgm
.section .rodata,"a"
.p2align 6
.amdhsa_kernel standalone__sliding_block_cached__sampling_kernel
  .amdhsa_next_free_vgpr 256
  .amdhsa_next_free_sgpr 102
  .amdhsa_accum_offset 256
  .amdhsa_group_segment_fixed_size 0
  .amdhsa_kernarg_size 64
  .amdhsa_user_sgpr_count 2
  .amdhsa_user_sgpr_kernarg_segment_ptr 1
  .amdhsa_system_sgpr_workgroup_id_x 1
  .amdhsa_float_denorm_mode_32 3
.end_amdhsa_kernel
```
